```python
import torch

def _softmax(x, axis=-1):
    return torch.softmax(x, dim=axis)
def _gelu(x):
    return torch.nn.functional.gelu(x, approximate="tanh")
def _silu(x):
    return torch.nn.functional.silu(x)
def _sigmoid(x):
    return torch.sigmoid(x)
def _layernorm(x, axis=-1, eps=1e-5):
    m = x.mean(dim=axis, keepdim=True)
    v = x.var(dim=axis, keepdim=True, unbiased=False)
    return (x - m) / torch.sqrt(v + eps)
def _scatter_add(tgt, idx, src, axis=0):
    return tgt.clone().index_add_(axis, idx, src)
def _segment_sum(src, seg, n):
    out = torch.zeros((n,) + src.shape[1:], dtype=src.dtype)
    return out.index_add_(0, seg, src)
def _pad(x, pw):
    flat = tuple(v for pair in reversed(pw) for v in pair)
    return torch.nn.functional.pad(x, flat)

kernel_name = 'standalone__molecular_angular_gemnet__graph'

def setup_inputs():

    _w = (lambda a: (lambda t: t.to(torch.bfloat16) if t.is_floating_point() else t)(torch.as_tensor(a)))
    N, deg, De, L = 25000, 16, 4, 3
    E = N * deg
    T = E * deg
    NR = 8
    dist = torch.rand(E).to(float)
    angle = (torch.rand(T) * torch.pi).to(float)
    centers = torch.linspace(0.0, 1.0, NR).to(float)
    ang_freq = torch.arange(1, L + 1).to(float)
    return {
        "m": _w((lambda *s: torch.randn(*s, dtype=torch.bfloat16) * 0.05)(E, De)),
        "idx_in": _w((lambda lo, hi, *s: torch.randint(lo, hi, s))(0, E, T).to(torch.int64)),
        "idx_out": _w((lambda lo, hi, *s: torch.randint(lo, hi, s))(0, E, T).to(torch.int64)),
        "dist": _w(dist),
        "angle": _w(angle),
        "centers": _w(centers),
        "ang_freq": _w(ang_freq),
        "w_rbf": _w((lambda *s: torch.randn(*s, dtype=torch.bfloat16) * 0.4)(NR, De)),
        "w_sbf": _w((lambda *s: torch.randn(*s, dtype=torch.bfloat16) * 0.4)(NR * L, De)),
        "w_down": _w((lambda *s: torch.randn(*s, dtype=torch.bfloat16) * 0.4)(De, De)),
        "w_up": _w((lambda *s: torch.randn(*s, dtype=torch.bfloat16) * 0.4)(De, De)),
    }

def reference(m, idx_in, idx_out, dist, angle, centers, ang_freq, w_rbf, w_sbf, w_down, w_up):
    E, De = m.shape[0], m.shape[1]
    NR = centers.shape[0]
    L = ang_freq.shape[0]
    rbf = torch.exp(-10.0 * (dist[:, None] - centers[None, :]) ** 2)
    cbf = torch.cos(ang_freq[None, :] * angle[:, None])
    rbf_t = rbf[idx_out]
    sbf = torch.reshape(rbf_t[:, :, None] * cbf[:, None, :], (-1, NR * L))
    x = (m[idx_in] @ w_down) * (sbf @ w_sbf)
    agg = _segment_sum(x, idx_out, E)
    return m + (agg @ w_up) * (rbf @ w_rbf)
```

```asm
; @launch kernel=gp1_kernel grid=(250,1,1) block=(640,1,1) lds=106528
; @launch kernel=gp2_kernel grid=(256,1,1) block=(1024,1,1) lds=148992
.amdgcn_target "amdgcn-amd-amdhsa--gfx950"
.text
.globl gp1_kernel
.p2align 8
.type gp1_kernel,@function
gp1_kernel:
    s_cmp_ge_u32 s2, 250
    s_cbranch_scc1 P1_END
    s_load_dwordx4 s[48:51], s[0:1], 0
    s_load_dwordx2 s[52:53], s[0:1], 16
    s_load_dwordx4 s[56:59], s[0:1], 32
    s_load_dwordx4 s[60:63], s[0:1], 56
    s_load_dwordx2 s[64:65], s[0:1], 72
    s_load_dwordx2 s[12:13], s[0:1], 104
    v_lshlrev_b32 v1, 3, v0
    v_lshlrev_b32 v2, 4, v0
    v_mov_b32 v6, 0
    v_mov_b32 v7, 0
    v_mov_b32 v8, 0
    v_mov_b32 v9, 0
    v_mov_b32 v3, 1
    v_add_u32 v4, 102400, v2
    v_lshrrev_b32 v140, 6, v0
    s_nop 0
    v_readfirstlane_b32 s4, v140
    s_mov_b32 s3, s2
    s_mov_b32 s5, 0xffff0000
    s_cmp_ge_u32 s4, 4
    s_cbranch_scc1 P1_Z0
    ds_write_b128 v4, v[6:9]
P1_Z0:
    v_lshrrev_b32 v5, 1, v0
    s_mov_b32 s14, 16000
    v_mul_lo_u32 v5, v5, s14
    v_and_b32 v140, 1, v0
    v_lshl_add_u32 v5, v140, 4, v5
    s_waitcnt lgkmcnt(0)
    s_mov_b32 s16, s50
    s_mov_b32 s17, s51
    s_mov_b32 s18, 0x186a000
    s_mov_b32 s19, 0x20000
    s_mov_b32 s20, s52
    s_mov_b32 s21, s53
    s_mov_b32 s22, 0x186a000
    s_mov_b32 s23, 0x20000
    s_mov_b32 s24, s56
    s_mov_b32 s25, s57
    s_mov_b32 s26, 0xc35000
    s_mov_b32 s27, 0x20000
    s_mul_i32 s8, s3, 51200
    s_mul_i32 s9, s3, 25600
    buffer_load_dwordx4 v[10:13], v2, s[16:19], s8 offen nt
    buffer_load_dwordx4 v[30:33], v2, s[20:23], s8 offen nt
    buffer_load_dwordx2 v[50:51], v1, s[24:27], s9 offen nt
    s_add_u32 s8, s8, 10240
    s_add_u32 s9, s9, 5120
    buffer_load_dwordx4 v[14:17], v2, s[16:19], s8 offen nt
    buffer_load_dwordx4 v[34:37], v2, s[20:23], s8 offen nt
    buffer_load_dwordx2 v[52:53], v1, s[24:27], s9 offen nt
    s_add_u32 s8, s8, 10240
    s_add_u32 s9, s9, 5120
    buffer_load_dwordx4 v[18:21], v2, s[16:19], s8 offen nt
    buffer_load_dwordx4 v[38:41], v2, s[20:23], s8 offen nt
    buffer_load_dwordx2 v[54:55], v1, s[24:27], s9 offen nt
    s_add_u32 s8, s8, 10240
    s_add_u32 s9, s9, 5120
    buffer_load_dwordx4 v[22:25], v2, s[16:19], s8 offen nt
    buffer_load_dwordx4 v[42:45], v2, s[20:23], s8 offen nt
    buffer_load_dwordx2 v[56:57], v1, s[24:27], s9 offen nt
    s_add_u32 s8, s8, 10240
    s_add_u32 s9, s9, 5120
    buffer_load_dwordx4 v[26:29], v2, s[16:19], s8 offen nt
    buffer_load_dwordx4 v[46:49], v2, s[20:23], s8 offen nt
    buffer_load_dwordx2 v[58:59], v1, s[24:27], s9 offen nt
    s_mov_b32 s28, s48
    s_mov_b32 s29, s49
    s_mov_b32 s30, 0x30d400
    s_mov_b32 s31, 0x20000
    s_mul_i32 s6, s2, 12800
    v_add_u32 v60, 0, v1
    buffer_load_dwordx2 v[64:65], v60, s[28:31], s6 offen
    v_add_u32 v61, 5120, v1
    buffer_load_dwordx2 v[66:67], v61, s[28:31], s6 offen
    v_add_u32 v62, 10240, v1
    v_cmp_gt_u32 vcc, 320, v0
    v_mov_b32 v140, 0x7ffffff0
    s_nop 0
    v_cndmask_b32 v62, v140, v62, vcc
    buffer_load_dwordx2 v[68:69], v62, s[28:31], s6 offen
    s_mov_b32 s14, s60
    s_mov_b32 s15, s61
    s_mov_b32 s10, s62
    s_mov_b32 s11, s63
    s_load_dwordx8 s[40:47], s[64:65], 0
    s_load_dwordx4 s[96:99], s[58:59], 0
    s_load_dwordx16 s[48:63], s[10:11], 0
    s_load_dwordx16 s[64:79], s[10:11], 64
    s_load_dwordx16 s[80:95], s[10:11], 128
    s_waitcnt lgkmcnt(0)
    s_pack_ll_b32_b16 s32, s40, s42
    s_pack_ll_b32_b16 s33, s44, s46
    s_pack_hh_b32_b16 s34, s40, s42
    s_pack_hh_b32_b16 s35, s44, s46
    s_pack_ll_b32_b16 s36, s41, s43
    s_pack_ll_b32_b16 s37, s45, s47
    s_pack_hh_b32_b16 s38, s41, s43
    s_pack_hh_b32_b16 s39, s45, s47
    s_add_u32 s40, s12, 0x7000000
    s_addc_u32 s41, s13, 0
    s_mov_b32 s42, 0x30d400
    s_mov_b32 s43, 0x20000
    s_add_u32 s44, s12, 0x7800000
    s_addc_u32 s45, s13, 0
    s_mov_b32 s46, 0x280000
    s_mov_b32 s47, 0x20000
    s_cmp_lt_u32 s4, 2
    s_cbranch_scc1 P1_TB1
    s_cmp_ge_u32 s2, 128
    s_cbranch_scc1 P1_TB1
    s_mov_b32 s8, s48
    s_mov_b32 s9, s49
    s_mov_b32 s10, s54
    s_mov_b32 s11, s55
    s_pack_ll_b32_b16 s48, s8, s10
    s_pack_hh_b32_b16 s49, s8, s10
    s_pack_ll_b32_b16 s54, s9, s11
    s_pack_hh_b32_b16 s55, s9, s11
    s_mov_b32 s8, s50
    s_mov_b32 s9, s51
    s_mov_b32 s10, s56
    s_mov_b32 s11, s57
    s_pack_ll_b32_b16 s50, s8, s10
    s_pack_hh_b32_b16 s51, s8, s10
    s_pack_ll_b32_b16 s56, s9, s11
    s_pack_hh_b32_b16 s57, s9, s11
    s_mov_b32 s8, s52
    s_mov_b32 s9, s53
    s_mov_b32 s10, s58
    s_mov_b32 s11, s59
    s_pack_ll_b32_b16 s52, s8, s10
    s_pack_hh_b32_b16 s53, s8, s10
    s_pack_ll_b32_b16 s58, s9, s11
    s_pack_hh_b32_b16 s59, s9, s11
    s_mov_b32 s8, s60
    s_mov_b32 s9, s61
    s_mov_b32 s10, s66
    s_mov_b32 s11, s67
    s_pack_ll_b32_b16 s60, s8, s10
    s_pack_hh_b32_b16 s61, s8, s10
    s_pack_ll_b32_b16 s66, s9, s11
    s_pack_hh_b32_b16 s67, s9, s11
    s_mov_b32 s8, s62
    s_mov_b32 s9, s63
    s_mov_b32 s10, s68
    s_mov_b32 s11, s69
    s_pack_ll_b32_b16 s62, s8, s10
    s_pack_hh_b32_b16 s63, s8, s10
    s_pack_ll_b32_b16 s68, s9, s11
    s_pack_hh_b32_b16 s69, s9, s11
    s_mov_b32 s8, s64
    s_mov_b32 s9, s65
    s_mov_b32 s10, s70
    s_mov_b32 s11, s71
    s_pack_ll_b32_b16 s64, s8, s10
    s_pack_hh_b32_b16 s65, s8, s10
    s_pack_ll_b32_b16 s70, s9, s11
    s_pack_hh_b32_b16 s71, s9, s11
    s_mov_b32 s8, s72
    s_mov_b32 s9, s73
    s_mov_b32 s10, s78
    s_mov_b32 s11, s79
    s_pack_ll_b32_b16 s72, s8, s10
    s_pack_hh_b32_b16 s73, s8, s10
    s_pack_ll_b32_b16 s78, s9, s11
    s_pack_hh_b32_b16 s79, s9, s11
    s_mov_b32 s8, s74
    s_mov_b32 s9, s75
    s_mov_b32 s10, s80
    s_mov_b32 s11, s81
    s_pack_ll_b32_b16 s74, s8, s10
    s_pack_hh_b32_b16 s75, s8, s10
    s_pack_ll_b32_b16 s80, s9, s11
    s_pack_hh_b32_b16 s81, s9, s11
    s_mov_b32 s8, s76
    s_mov_b32 s9, s77
    s_mov_b32 s10, s82
    s_mov_b32 s11, s83
    s_pack_ll_b32_b16 s76, s8, s10
    s_pack_hh_b32_b16 s77, s8, s10
    s_pack_ll_b32_b16 s82, s9, s11
    s_pack_hh_b32_b16 s83, s9, s11
    s_mov_b32 s8, s84
    s_mov_b32 s9, s85
    s_mov_b32 s10, s90
    s_mov_b32 s11, s91
    s_pack_ll_b32_b16 s84, s8, s10
    s_pack_hh_b32_b16 s85, s8, s10
    s_pack_ll_b32_b16 s90, s9, s11
    s_pack_hh_b32_b16 s91, s9, s11
    s_mov_b32 s8, s86
    s_mov_b32 s9, s87
    s_mov_b32 s10, s92
    s_mov_b32 s11, s93
    s_pack_ll_b32_b16 s86, s8, s10
    s_pack_hh_b32_b16 s87, s8, s10
    s_pack_ll_b32_b16 s92, s9, s11
    s_pack_hh_b32_b16 s93, s9, s11
    s_mov_b32 s8, s88
    s_mov_b32 s9, s89
    s_mov_b32 s10, s94
    s_mov_b32 s11, s95
    s_pack_ll_b32_b16 s88, s8, s10
    s_pack_hh_b32_b16 s89, s8, s10
    s_pack_ll_b32_b16 s94, s9, s11
    s_pack_hh_b32_b16 s95, s9, s11
    s_mul_i32 s8, s2, 512
    v_subrev_u32 v74, 128, v0
    v_add_u32 v74, s8, v74
    v_lshlrev_b32 v75, 16, v74
    s_lshl_b32 s8, s96, 16
    v_subrev_f32 v76, s8, v75
    s_and_b32 s9, s96, 0xffff0000
    v_subrev_f32 v77, s9, v75
    s_lshl_b32 s10, s97, 16
    v_subrev_f32 v78, s10, v75
    s_and_b32 s11, s97, 0xffff0000
    v_subrev_f32 v79, s11, v75
    s_lshl_b32 s8, s98, 16
    v_subrev_f32 v80, s8, v75
    s_and_b32 s9, s98, 0xffff0000
    v_subrev_f32 v81, s9, v75
    s_lshl_b32 s10, s99, 16
    v_subrev_f32 v82, s10, v75
    s_and_b32 s11, s99, 0xffff0000
    v_subrev_f32 v83, s11, v75
    v_cvt_pk_bf16_f32 v76, 0, v76
    v_cvt_pk_bf16_f32 v77, 0, v77
    v_cvt_pk_bf16_f32 v78, 0, v78
    v_cvt_pk_bf16_f32 v79, 0, v79
    v_cvt_pk_bf16_f32 v80, 0, v80
    v_cvt_pk_bf16_f32 v81, 0, v81
    v_cvt_pk_bf16_f32 v82, 0, v82
    v_cvt_pk_bf16_f32 v83, 0, v83
    v_mul_f32 v76, v76, v76
    v_mul_f32 v77, v77, v77
    v_mul_f32 v78, v78, v78
    v_mul_f32 v79, v79, v79
    v_mul_f32 v80, v80, v80
    v_mul_f32 v81, v81, v81
    v_mul_f32 v82, v82, v82
    v_mul_f32 v83, v83, v83
    v_cvt_pk_bf16_f32 v76, 0, v76
    v_cvt_pk_bf16_f32 v77, 0, v77
    v_cvt_pk_bf16_f32 v78, 0, v78
    v_cvt_pk_bf16_f32 v79, 0, v79
    v_cvt_pk_bf16_f32 v80, 0, v80
    v_cvt_pk_bf16_f32 v81, 0, v81
    v_cvt_pk_bf16_f32 v82, 0, v82
    v_cvt_pk_bf16_f32 v83, 0, v83
    v_mul_f32 v76, 0xc1200000, v76
    v_mul_f32 v77, 0xc1200000, v77
    v_mul_f32 v78, 0xc1200000, v78
    v_mul_f32 v79, 0xc1200000, v79
    v_mul_f32 v80, 0xc1200000, v80
    v_mul_f32 v81, 0xc1200000, v81
    v_mul_f32 v82, 0xc1200000, v82
    v_mul_f32 v83, 0xc1200000, v83
    v_cvt_pk_bf16_f32 v76, 0, v76
    v_cvt_pk_bf16_f32 v77, 0, v77
    v_cvt_pk_bf16_f32 v78, 0, v78
    v_cvt_pk_bf16_f32 v79, 0, v79
    v_cvt_pk_bf16_f32 v80, 0, v80
    v_cvt_pk_bf16_f32 v81, 0, v81
    v_cvt_pk_bf16_f32 v82, 0, v82
    v_cvt_pk_bf16_f32 v83, 0, v83
    v_mul_f32 v76, 0x3fb8aa3b, v76
    v_mul_f32 v77, 0x3fb8aa3b, v77
    v_mul_f32 v78, 0x3fb8aa3b, v78
    v_mul_f32 v79, 0x3fb8aa3b, v79
    v_mul_f32 v80, 0x3fb8aa3b, v80
    v_mul_f32 v81, 0x3fb8aa3b, v81
    v_mul_f32 v82, 0x3fb8aa3b, v82
    v_mul_f32 v83, 0x3fb8aa3b, v83
    v_exp_f32 v76, v76
    v_exp_f32 v77, v77
    v_exp_f32 v78, v78
    v_exp_f32 v79, v79
    v_exp_f32 v80, v80
    v_exp_f32 v81, v81
    v_exp_f32 v82, v82
    v_exp_f32 v83, v83
    v_cvt_pk_bf16_f32 v84, v76, v77
    v_cvt_pk_bf16_f32 v85, v78, v79
    v_cvt_pk_bf16_f32 v86, v80, v81
    v_cvt_pk_bf16_f32 v87, v82, v83
    v_dot2_f32_bf16 v88, v84, s48, 0
    v_dot2_f32_bf16 v89, v84, s49, 0
    v_dot2_f32_bf16 v90, v84, s54, 0
    v_dot2_f32_bf16 v91, v84, s55, 0
    v_dot2_f32_bf16 v92, v84, s50, 0
    v_dot2_f32_bf16 v93, v84, s51, 0
    v_dot2_f32_bf16 v94, v84, s56, 0
    v_dot2_f32_bf16 v95, v84, s57, 0
    v_dot2_f32_bf16 v96, v84, s52, 0
    v_dot2_f32_bf16 v97, v84, s53, 0
    v_dot2_f32_bf16 v98, v84, s58, 0
    v_dot2_f32_bf16 v99, v84, s59, 0
    v_dot2_f32_bf16 v88, v85, s60, v88
    v_dot2_f32_bf16 v89, v85, s61, v89
    v_dot2_f32_bf16 v90, v85, s66, v90
    v_dot2_f32_bf16 v91, v85, s67, v91
    v_dot2_f32_bf16 v92, v85, s62, v92
    v_dot2_f32_bf16 v93, v85, s63, v93
    v_dot2_f32_bf16 v94, v85, s68, v94
    v_dot2_f32_bf16 v95, v85, s69, v95
    v_dot2_f32_bf16 v96, v85, s64, v96
    v_dot2_f32_bf16 v97, v85, s65, v97
    v_dot2_f32_bf16 v98, v85, s70, v98
    v_dot2_f32_bf16 v99, v85, s71, v99
    v_dot2_f32_bf16 v88, v86, s72, v88
    v_dot2_f32_bf16 v89, v86, s73, v89
    v_dot2_f32_bf16 v90, v86, s78, v90
    v_dot2_f32_bf16 v91, v86, s79, v91
    v_dot2_f32_bf16 v92, v86, s74, v92
    v_dot2_f32_bf16 v93, v86, s75, v93
    v_dot2_f32_bf16 v94, v86, s80, v94
    v_dot2_f32_bf16 v95, v86, s81, v95
    v_dot2_f32_bf16 v96, v86, s76, v96
    v_dot2_f32_bf16 v97, v86, s77, v97
    v_dot2_f32_bf16 v98, v86, s82, v98
    v_dot2_f32_bf16 v99, v86, s83, v99
    v_dot2_f32_bf16 v88, v87, s84, v88
    v_dot2_f32_bf16 v89, v87, s85, v89
    v_dot2_f32_bf16 v90, v87, s90, v90
    v_dot2_f32_bf16 v91, v87, s91, v91
    v_dot2_f32_bf16 v92, v87, s86, v92
    v_dot2_f32_bf16 v93, v87, s87, v93
    v_dot2_f32_bf16 v94, v87, s92, v94
    v_dot2_f32_bf16 v95, v87, s93, v95
    v_dot2_f32_bf16 v96, v87, s88, v96
    v_dot2_f32_bf16 v97, v87, s89, v97
    v_dot2_f32_bf16 v98, v87, s94, v98
    v_dot2_f32_bf16 v99, v87, s95, v99
    s_load_dwordx16 s[48:63], s[14:15], 0
    v_add_f32 v100, |v88|, |v92|
    v_add_f32 v101, |v89|, |v93|
    v_add_f32 v102, |v90|, |v94|
    v_add_f32 v103, |v91|, |v95|
    v_add_f32 v100, v100, |v96|
    v_add_f32 v101, v101, |v97|
    v_add_f32 v102, v102, |v98|
    v_add_f32 v103, v103, |v99|
    v_add_f32 v76, v100, v101
    v_add_f32 v77, v102, v103
    v_add_f32 v76, v76, v77
    v_cmp_gt_u32 vcc, 0x7f000000, v76
    v_frexp_exp_i32_f32 v100, v100
    v_frexp_exp_i32_f32 v101, v101
    v_frexp_exp_i32_f32 v102, v102
    v_frexp_exp_i32_f32 v103, v103
    s_movk_i32 s8, -60
    v_med3_i32 v100, v100, s8, 60
    v_med3_i32 v101, v101, s8, 60
    v_med3_i32 v102, v102, s8, 60
    v_med3_i32 v103, v103, s8, 60
    v_and_b32 v75, 0xff, v100
    v_and_b32 v77, 0xff, v101
    v_lshl_or_b32 v75, v77, 8, v75
    v_and_b32 v78, 0xff, v102
    v_lshl_or_b32 v75, v78, 16, v75
    v_and_b32 v79, 0xff, v103
    v_lshl_or_b32 v75, v79, 24, v75
    v_sub_u32 v100, 0, v100
    v_sub_u32 v101, 0, v101
    v_sub_u32 v102, 0, v102
    v_sub_u32 v103, 0, v103
    v_ldexp_f32 v88, v88, v100
    v_ldexp_f32 v89, v89, v101
    v_ldexp_f32 v90, v90, v102
    v_ldexp_f32 v91, v91, v103
    v_ldexp_f32 v92, v92, v100
    v_ldexp_f32 v93, v93, v101
    v_ldexp_f32 v94, v94, v102
    v_ldexp_f32 v95, v95, v103
    v_ldexp_f32 v96, v96, v100
    v_ldexp_f32 v97, v97, v101
    v_ldexp_f32 v98, v98, v102
    v_ldexp_f32 v99, v99, v103
    v_mov_b32 v83, 1
    v_cndmask_b32 v73, v83, v6, vcc
    v_cvt_pk_bf16_f32 v76, v88, v92
    v_cvt_pk_bf16_f32 v77, v89, v93
    v_cvt_pk_bf16_f32 v78, v90, v94
    v_cvt_pk_bf16_f32 v79, v91, v95
    v_cvt_pk_bf16_f32 v80, v96, v97
    v_cvt_pk_bf16_f32 v81, v98, v99
    s_waitcnt lgkmcnt(0)
    s_mov_b32 s8, s48
    s_mov_b32 s9, s49
    s_mov_b32 s10, s50
    s_mov_b32 s11, s51
    s_pack_ll_b32_b16 s48, s8, s10
    s_pack_hh_b32_b16 s49, s8, s10
    s_pack_ll_b32_b16 s50, s9, s11
    s_pack_hh_b32_b16 s51, s9, s11
    s_mov_b32 s8, s52
    s_mov_b32 s9, s53
    s_mov_b32 s10, s54
    s_mov_b32 s11, s55
    s_pack_ll_b32_b16 s52, s8, s10
    s_pack_hh_b32_b16 s53, s8, s10
    s_pack_ll_b32_b16 s54, s9, s11
    s_pack_hh_b32_b16 s55, s9, s11
    s_mov_b32 s8, s56
    s_mov_b32 s9, s57
    s_mov_b32 s10, s58
    s_mov_b32 s11, s59
    s_pack_ll_b32_b16 s56, s8, s10
    s_pack_hh_b32_b16 s57, s8, s10
    s_pack_ll_b32_b16 s58, s9, s11
    s_pack_hh_b32_b16 s59, s9, s11
    s_mov_b32 s8, s60
    s_mov_b32 s9, s61
    s_mov_b32 s10, s62
    s_mov_b32 s11, s63
    s_pack_ll_b32_b16 s60, s8, s10
    s_pack_hh_b32_b16 s61, s8, s10
    s_pack_ll_b32_b16 s62, s9, s11
    s_pack_hh_b32_b16 s63, s9, s11
    v_dot2_f32_bf16 v100, v84, s48, 0
    v_dot2_f32_bf16 v101, v84, s49, 0
    v_dot2_f32_bf16 v102, v84, s50, 0
    v_dot2_f32_bf16 v103, v84, s51, 0
    v_dot2_f32_bf16 v100, v85, s52, v100
    v_dot2_f32_bf16 v101, v85, s53, v101
    v_dot2_f32_bf16 v102, v85, s54, v102
    v_dot2_f32_bf16 v103, v85, s55, v103
    v_dot2_f32_bf16 v100, v86, s56, v100
    v_dot2_f32_bf16 v101, v86, s57, v101
    v_dot2_f32_bf16 v102, v86, s58, v102
    v_dot2_f32_bf16 v103, v86, s59, v103
    v_dot2_f32_bf16 v100, v87, s60, v100
    v_dot2_f32_bf16 v101, v87, s61, v101
    v_dot2_f32_bf16 v102, v87, s62, v102
    v_dot2_f32_bf16 v103, v87, s63, v103
    v_lshlrev_b32 v88, 5, v74
    v_lshlrev_b32 v89, 3, v74
    s_mov_b32 s9, 0x200000
    v_mov_b32 v82, v75
    v_mov_b32 v83, v73
    v_cvt_pk_bf16_f32 v90, v100, v101
    v_cvt_pk_bf16_f32 v91, v102, v103
    buffer_store_dwordx4 v[76:79], v88, s[44:47], 0 offen
    buffer_store_dwordx4 v[80:83], v88, s[44:47], 0 offen offset:16
    buffer_store_dwordx2 v[90:91], v89, s[44:47], s9 offen
P1_TB1:
    s_waitcnt vmcnt(0)
    v_mov_b32 v72, 0
    v_mov_b32 v73, 0
    s_mov_b32 s8, 0x7fff0000
    v_dot2_f32_bf16 v140, v65, s33, 0
    v_dot2_f32_bf16 v141, v65, s35, 0
    v_dot2_f32_bf16 v142, v65, s37, 0
    v_dot2_f32_bf16 v143, v65, s39, 0
    v_dot2_f32_bf16 v140, v64, s32, v140
    v_dot2_f32_bf16 v141, v64, s34, v141
    v_dot2_f32_bf16 v142, v64, s36, v142
    v_dot2_f32_bf16 v143, v64, s38, v143
    s_nop 0
    v_cvt_pk_bf16_f32 v64, v140, v141
    s_nop 0
    v_cvt_pk_bf16_f32 v65, v142, v143
    buffer_store_dwordx2 v[64:65], v60, s[40:43], s6 offen
    v_lshlrev_b32 v148, 16, v64
    v_and_b32 v149, s8, v64
    v_and_b32 v148, s8, v148
    v_max3_u32 v72, v72, v148, v149
    v_add_f32 v73, v73, v149
    v_add_f32 v73, v73, v148
    v_lshlrev_b32 v148, 16, v65
    v_and_b32 v149, s8, v65
    v_and_b32 v148, s8, v148
    v_max3_u32 v72, v72, v148, v149
    v_add_f32 v73, v73, v149
    v_add_f32 v73, v73, v148
    v_dot2_f32_bf16 v144, v67, s33, 0
    v_dot2_f32_bf16 v145, v67, s35, 0
    v_dot2_f32_bf16 v146, v67, s37, 0
    v_dot2_f32_bf16 v147, v67, s39, 0
    v_dot2_f32_bf16 v144, v66, s32, v144
    v_dot2_f32_bf16 v145, v66, s34, v145
    v_dot2_f32_bf16 v146, v66, s36, v146
    v_dot2_f32_bf16 v147, v66, s38, v147
    s_nop 0
    v_cvt_pk_bf16_f32 v66, v144, v145
    s_nop 0
    v_cvt_pk_bf16_f32 v67, v146, v147
    buffer_store_dwordx2 v[66:67], v61, s[40:43], s6 offen
    v_lshlrev_b32 v148, 16, v66
    v_and_b32 v149, s8, v66
    v_and_b32 v148, s8, v148
    v_max3_u32 v72, v72, v148, v149
    v_add_f32 v73, v73, v149
    v_add_f32 v73, v73, v148
    v_lshlrev_b32 v148, 16, v67
    v_and_b32 v149, s8, v67
    v_and_b32 v148, s8, v148
    v_max3_u32 v72, v72, v148, v149
    v_add_f32 v73, v73, v149
    v_add_f32 v73, v73, v148
    v_dot2_f32_bf16 v140, v69, s33, 0
    v_dot2_f32_bf16 v141, v69, s35, 0
    v_dot2_f32_bf16 v142, v69, s37, 0
    v_dot2_f32_bf16 v143, v69, s39, 0
    v_dot2_f32_bf16 v140, v68, s32, v140
    v_dot2_f32_bf16 v141, v68, s34, v141
    v_dot2_f32_bf16 v142, v68, s36, v142
    v_dot2_f32_bf16 v143, v68, s38, v143
    s_nop 0
    v_cvt_pk_bf16_f32 v68, v140, v141
    s_nop 0
    v_cvt_pk_bf16_f32 v69, v142, v143
    buffer_store_dwordx2 v[68:69], v62, s[40:43], s6 offen
    v_lshlrev_b32 v148, 16, v68
    v_and_b32 v149, s8, v68
    v_and_b32 v148, s8, v148
    v_max3_u32 v72, v72, v148, v149
    v_add_f32 v73, v73, v149
    v_add_f32 v73, v73, v148
    v_lshlrev_b32 v148, 16, v69
    v_and_b32 v149, s8, v69
    v_and_b32 v148, s8, v148
    v_max3_u32 v72, v72, v148, v149
    v_add_f32 v73, v73, v149
    v_add_f32 v73, v73, v148
    v_max_u32_dpp v72, v72, v72 row_shr:1 row_mask:0xf bank_mask:0xf bound_ctrl:0
    s_nop 1
    v_max_u32_dpp v72, v72, v72 row_shr:2 row_mask:0xf bank_mask:0xf bound_ctrl:0
    s_nop 1
    v_max_u32_dpp v72, v72, v72 row_shr:4 row_mask:0xf bank_mask:0xf bound_ctrl:0
    s_nop 1
    v_max_u32_dpp v72, v72, v72 row_shr:8 row_mask:0xf bank_mask:0xf bound_ctrl:0
    s_nop 1
    v_max_u32_dpp v72, v72, v72 row_bcast:15 row_mask:0xa bank_mask:0xf
    s_nop 1
    v_max_u32_dpp v72, v72, v72 row_bcast:31 row_mask:0xc bank_mask:0xf
    v_add_f32_dpp v73, v73, v73 row_shr:1 row_mask:0xf bank_mask:0xf bound_ctrl:0
    s_nop 1
    v_add_f32_dpp v73, v73, v73 row_shr:2 row_mask:0xf bank_mask:0xf bound_ctrl:0
    s_nop 1
    v_add_f32_dpp v73, v73, v73 row_shr:4 row_mask:0xf bank_mask:0xf bound_ctrl:0
    s_nop 1
    v_add_f32_dpp v73, v73, v73 row_shr:8 row_mask:0xf bank_mask:0xf bound_ctrl:0
    s_nop 1
    v_add_f32_dpp v73, v73, v73 row_bcast:15 row_mask:0xa bank_mask:0xf
    s_nop 1
    v_add_f32_dpp v73, v73, v73 row_bcast:31 row_mask:0xc bank_mask:0xf
    s_add_u32 s44, s12, 0x7600000
    s_addc_u32 s45, s13, 0
    s_mov_b32 s46, 0x10000
    s_mov_b32 s47, 0x20000
    s_mul_i32 s8, s2, 10
    s_add_u32 s8, s8, s4
    s_lshl_b32 s8, s8, 2
    v_readlane_b32 s9, v72, 63
    v_readlane_b32 s10, v73, 63
    s_add_u32 s11, s8, 0x4000
    v_mov_b32 v72, s9
    v_mov_b32 v73, s10
    s_mov_b64 exec, 1
    buffer_store_dword v72, v6, s[44:47], s8 offen
    buffer_store_dword v73, v6, s[44:47], s11 offen
    s_mov_b64 exec, -1
    s_nop 4
    s_mov_b32 s40, s12
    s_mov_b32 s41, s13
    s_mov_b32 s42, 0x30d4000
    s_mov_b32 s43, 0x20000
    s_add_u32 s44, s12, 0x6000000
    s_addc_u32 s45, s13, 0
    s_mov_b32 s46, 0x1f4000
    s_mov_b32 s47, 0x20000
    s_mov_b32 s13, 39768
    s_mov_b32 s12, 102400
    s_mov_b32 s6, 2739138
    s_mov_b32 s7, -784
    s_waitcnt vmcnt(0) lgkmcnt(0)
P1_LOOP:
    s_barrier
    s_cmp_eq_u32 s3, 499
    s_cselect_b32 s10, 5, 5
    s_waitcnt vmcnt(23)
    v_mul_hi_u32_u24 v140, s6, v30
    v_add_u32 v144, 32000, v10
    v_mul_hi_u32_u24 v144, s13, v144
    v_mul_hi_u32_u24 v141, s6, v31
    v_add_u32 v145, 32000, v11
    v_mul_hi_u32_u24 v145, s13, v145
    v_mul_hi_u32_u24 v142, s6, v32
    v_add_u32 v146, 32000, v12
    v_mul_hi_u32_u24 v146, s13, v146
    v_mul_hi_u32_u24 v143, s6, v33
    v_add_u32 v147, 32000, v13
    v_mul_hi_u32_u24 v147, s13, v147
    v_lshl_add_u32 v100, v140, 4, s12
    v_lshlrev_b32 v60, 3, v10
    v_lshlrev_b32 v140, 3, v140
    v_lshlrev_b32 v61, 2, v30
    v_lshl_add_u32 v100, v144, 2, v100
    v_mad_i32_i24 v61, v140, s7, v61
    v_lshl_or_b32 v61, v50, 16, v61
    v_lshl_add_u32 v101, v141, 4, s12
    v_lshlrev_b32 v62, 3, v11
    v_lshlrev_b32 v141, 3, v141
    v_lshlrev_b32 v63, 2, v31
    v_lshl_add_u32 v101, v145, 2, v101
    v_mad_i32_i24 v63, v141, s7, v63
    v_and_or_b32 v63, v50, s5, v63
    v_lshl_add_u32 v102, v142, 4, s12
    v_lshlrev_b32 v64, 3, v12
    v_lshlrev_b32 v142, 3, v142
    v_lshlrev_b32 v65, 2, v32
    v_lshl_add_u32 v102, v146, 2, v102
    v_mad_i32_i24 v65, v142, s7, v65
    v_lshl_or_b32 v65, v51, 16, v65
    v_lshl_add_u32 v103, v143, 4, s12
    v_lshlrev_b32 v66, 3, v13
    v_lshlrev_b32 v143, 3, v143
    v_lshlrev_b32 v67, 2, v33
    v_lshl_add_u32 v103, v147, 2, v103
    v_mad_i32_i24 v67, v143, s7, v67
    v_and_or_b32 v67, v51, s5, v67
    ds_add_rtn_u32 v120, v100, v3
    ds_add_rtn_u32 v121, v101, v3
    ds_add_rtn_u32 v122, v102, v3
    ds_add_rtn_u32 v123, v103, v3
    s_waitcnt vmcnt(20)
    v_mul_hi_u32_u24 v140, s6, v34
    v_add_u32 v144, 32000, v14
    v_mul_hi_u32_u24 v144, s13, v144
    v_mul_hi_u32_u24 v141, s6, v35
    v_add_u32 v145, 32000, v15
    v_mul_hi_u32_u24 v145, s13, v145
    v_mul_hi_u32_u24 v142, s6, v36
    v_add_u32 v146, 32000, v16
    v_mul_hi_u32_u24 v146, s13, v146
    v_mul_hi_u32_u24 v143, s6, v37
    v_add_u32 v147, 32000, v17
    v_mul_hi_u32_u24 v147, s13, v147
    v_lshl_add_u32 v104, v140, 4, s12
    v_lshlrev_b32 v68, 3, v14
    v_lshlrev_b32 v140, 3, v140
    v_lshlrev_b32 v69, 2, v34
    v_lshl_add_u32 v104, v144, 2, v104
    v_mad_i32_i24 v69, v140, s7, v69
    v_lshl_or_b32 v69, v52, 16, v69
    v_lshl_add_u32 v105, v141, 4, s12
    v_lshlrev_b32 v70, 3, v15
    v_lshlrev_b32 v141, 3, v141
    v_lshlrev_b32 v71, 2, v35
    v_lshl_add_u32 v105, v145, 2, v105
    v_mad_i32_i24 v71, v141, s7, v71
    v_and_or_b32 v71, v52, s5, v71
    v_lshl_add_u32 v106, v142, 4, s12
    v_lshlrev_b32 v72, 3, v16
    v_lshlrev_b32 v142, 3, v142
    v_lshlrev_b32 v73, 2, v36
    v_lshl_add_u32 v106, v146, 2, v106
    v_mad_i32_i24 v73, v142, s7, v73
    v_lshl_or_b32 v73, v53, 16, v73
    v_lshl_add_u32 v107, v143, 4, s12
    v_lshlrev_b32 v74, 3, v17
    v_lshlrev_b32 v143, 3, v143
    v_lshlrev_b32 v75, 2, v37
    v_lshl_add_u32 v107, v147, 2, v107
    v_mad_i32_i24 v75, v143, s7, v75
    v_and_or_b32 v75, v53, s5, v75
    ds_add_rtn_u32 v124, v104, v3
    ds_add_rtn_u32 v125, v105, v3
    ds_add_rtn_u32 v126, v106, v3
    ds_add_rtn_u32 v127, v107, v3
    s_waitcnt vmcnt(17)
    v_mul_hi_u32_u24 v140, s6, v38
    v_add_u32 v144, 32000, v18
    v_mul_hi_u32_u24 v144, s13, v144
    v_mul_hi_u32_u24 v141, s6, v39
    v_add_u32 v145, 32000, v19
    v_mul_hi_u32_u24 v145, s13, v145
    v_mul_hi_u32_u24 v142, s6, v40
    v_add_u32 v146, 32000, v20
    v_mul_hi_u32_u24 v146, s13, v146
    v_mul_hi_u32_u24 v143, s6, v41
    v_add_u32 v147, 32000, v21
    v_mul_hi_u32_u24 v147, s13, v147
    v_lshl_add_u32 v108, v140, 4, s12
    v_lshlrev_b32 v76, 3, v18
    v_lshlrev_b32 v140, 3, v140
    v_lshlrev_b32 v77, 2, v38
    v_lshl_add_u32 v108, v144, 2, v108
    v_mad_i32_i24 v77, v140, s7, v77
    v_lshl_or_b32 v77, v54, 16, v77
    v_lshl_add_u32 v109, v141, 4, s12
    v_lshlrev_b32 v78, 3, v19
    v_lshlrev_b32 v141, 3, v141
    v_lshlrev_b32 v79, 2, v39
    v_lshl_add_u32 v109, v145, 2, v109
    v_mad_i32_i24 v79, v141, s7, v79
    v_and_or_b32 v79, v54, s5, v79
    v_lshl_add_u32 v110, v142, 4, s12
    v_lshlrev_b32 v80, 3, v20
    v_lshlrev_b32 v142, 3, v142
    v_lshlrev_b32 v81, 2, v40
    v_lshl_add_u32 v110, v146, 2, v110
    v_mad_i32_i24 v81, v142, s7, v81
    v_lshl_or_b32 v81, v55, 16, v81
    v_lshl_add_u32 v111, v143, 4, s12
    v_lshlrev_b32 v82, 3, v21
    v_lshlrev_b32 v143, 3, v143
    v_lshlrev_b32 v83, 2, v41
    v_lshl_add_u32 v111, v147, 2, v111
    v_mad_i32_i24 v83, v143, s7, v83
    v_and_or_b32 v83, v55, s5, v83
    ds_add_rtn_u32 v128, v108, v3
    ds_add_rtn_u32 v129, v109, v3
    ds_add_rtn_u32 v130, v110, v3
    ds_add_rtn_u32 v131, v111, v3
    s_waitcnt vmcnt(14)
    v_mul_hi_u32_u24 v140, s6, v42
    v_add_u32 v144, 32000, v22
    v_mul_hi_u32_u24 v144, s13, v144
    v_mul_hi_u32_u24 v141, s6, v43
    v_add_u32 v145, 32000, v23
    v_mul_hi_u32_u24 v145, s13, v145
    v_mul_hi_u32_u24 v142, s6, v44
    v_add_u32 v146, 32000, v24
    v_mul_hi_u32_u24 v146, s13, v146
    v_mul_hi_u32_u24 v143, s6, v45
    v_add_u32 v147, 32000, v25
    v_mul_hi_u32_u24 v147, s13, v147
    v_lshl_add_u32 v112, v140, 4, s12
    v_lshlrev_b32 v84, 3, v22
    v_lshlrev_b32 v140, 3, v140
    v_lshlrev_b32 v85, 2, v42
    v_lshl_add_u32 v112, v144, 2, v112
    v_mad_i32_i24 v85, v140, s7, v85
    v_lshl_or_b32 v85, v56, 16, v85
    v_lshl_add_u32 v113, v141, 4, s12
    v_lshlrev_b32 v86, 3, v23
    v_lshlrev_b32 v141, 3, v141
    v_lshlrev_b32 v87, 2, v43
    v_lshl_add_u32 v113, v145, 2, v113
    v_mad_i32_i24 v87, v141, s7, v87
    v_and_or_b32 v87, v56, s5, v87
    v_lshl_add_u32 v114, v142, 4, s12
    v_lshlrev_b32 v88, 3, v24
    v_lshlrev_b32 v142, 3, v142
    v_lshlrev_b32 v89, 2, v44
    v_lshl_add_u32 v114, v146, 2, v114
    v_mad_i32_i24 v89, v142, s7, v89
    v_lshl_or_b32 v89, v57, 16, v89
    v_lshl_add_u32 v115, v143, 4, s12
    v_lshlrev_b32 v90, 3, v25
    v_lshlrev_b32 v143, 3, v143
    v_lshlrev_b32 v91, 2, v45
    v_lshl_add_u32 v115, v147, 2, v115
    v_mad_i32_i24 v91, v143, s7, v91
    v_and_or_b32 v91, v57, s5, v91
    ds_add_rtn_u32 v132, v112, v3
    ds_add_rtn_u32 v133, v113, v3
    ds_add_rtn_u32 v134, v114, v3
    ds_add_rtn_u32 v135, v115, v3
    s_waitcnt vmcnt(11)
    v_mul_hi_u32_u24 v140, s6, v46
    v_add_u32 v144, 32000, v26
    v_mul_hi_u32_u24 v144, s13, v144
    v_mul_hi_u32_u24 v141, s6, v47
    v_add_u32 v145, 32000, v27
    v_mul_hi_u32_u24 v145, s13, v145
    v_mul_hi_u32_u24 v142, s6, v48
    v_add_u32 v146, 32000, v28
    v_mul_hi_u32_u24 v146, s13, v146
    v_mul_hi_u32_u24 v143, s6, v49
    v_add_u32 v147, 32000, v29
    v_mul_hi_u32_u24 v147, s13, v147
    v_lshl_add_u32 v116, v140, 4, s12
    v_lshlrev_b32 v92, 3, v26
    v_lshlrev_b32 v140, 3, v140
    v_lshlrev_b32 v93, 2, v46
    v_lshl_add_u32 v116, v144, 2, v116
    v_mad_i32_i24 v93, v140, s7, v93
    v_lshl_or_b32 v93, v58, 16, v93
    v_lshl_add_u32 v117, v141, 4, s12
    v_lshlrev_b32 v94, 3, v27
    v_lshlrev_b32 v141, 3, v141
    v_lshlrev_b32 v95, 2, v47
    v_lshl_add_u32 v117, v145, 2, v117
    v_mad_i32_i24 v95, v141, s7, v95
    v_and_or_b32 v95, v58, s5, v95
    v_lshl_add_u32 v118, v142, 4, s12
    v_lshlrev_b32 v96, 3, v28
    v_lshlrev_b32 v142, 3, v142
    v_lshlrev_b32 v97, 2, v48
    v_lshl_add_u32 v118, v146, 2, v118
    v_mad_i32_i24 v97, v142, s7, v97
    v_lshl_or_b32 v97, v59, 16, v97
    v_lshl_add_u32 v119, v143, 4, s12
    v_lshlrev_b32 v98, 3, v29
    v_lshlrev_b32 v143, 3, v143
    v_lshlrev_b32 v99, 2, v49
    v_lshl_add_u32 v119, v147, 2, v119
    v_mad_i32_i24 v99, v143, s7, v99
    v_and_or_b32 v99, v59, s5, v99
    ds_add_rtn_u32 v136, v116, v3
    ds_add_rtn_u32 v137, v117, v3
    ds_add_rtn_u32 v138, v118, v3
    ds_add_rtn_u32 v139, v119, v3
    s_add_u32 s14, s3, 250
    s_mul_i32 s8, s14, 51200
    s_mul_i32 s9, s14, 25600
    buffer_load_dwordx4 v[10:13], v2, s[16:19], s8 offen nt
    buffer_load_dwordx4 v[30:33], v2, s[20:23], s8 offen nt
    buffer_load_dwordx2 v[50:51], v1, s[24:27], s9 offen nt
    s_add_u32 s8, s8, 10240
    s_add_u32 s9, s9, 5120
    buffer_load_dwordx4 v[14:17], v2, s[16:19], s8 offen nt
    buffer_load_dwordx4 v[34:37], v2, s[20:23], s8 offen nt
    buffer_load_dwordx2 v[52:53], v1, s[24:27], s9 offen nt
    s_add_u32 s8, s8, 10240
    s_add_u32 s9, s9, 5120
    buffer_load_dwordx4 v[18:21], v2, s[16:19], s8 offen nt
    buffer_load_dwordx4 v[38:41], v2, s[20:23], s8 offen nt
    buffer_load_dwordx2 v[54:55], v1, s[24:27], s9 offen nt
    s_add_u32 s8, s8, 10240
    s_add_u32 s9, s9, 5120
    buffer_load_dwordx4 v[22:25], v2, s[16:19], s8 offen nt
    buffer_load_dwordx4 v[42:45], v2, s[20:23], s8 offen nt
    buffer_load_dwordx2 v[56:57], v1, s[24:27], s9 offen nt
    s_add_u32 s8, s8, 10240
    s_add_u32 s9, s9, 5120
    buffer_load_dwordx4 v[26:29], v2, s[16:19], s8 offen nt
    buffer_load_dwordx4 v[46:49], v2, s[20:23], s8 offen nt
    buffer_load_dwordx2 v[58:59], v1, s[24:27], s9 offen nt
    s_waitcnt lgkmcnt(0)
    s_barrier
    s_cmp_ge_u32 s4, 4
    s_cbranch_scc1 P1_S1
    ds_read_b128 v[140:143], v4
    s_waitcnt lgkmcnt(0)
    v_lshl_or_b32 v144, v141, 16, v140
    v_lshl_or_b32 v145, v143, 16, v142
    v_mov_b32 v146, v144
    v_mov_b32 v147, v145
    s_nop 0
    v_add_u32_dpp v146, v146, v146 row_shr:1 row_mask:0xf bank_mask:0xf bound_ctrl:0
    v_add_u32_dpp v147, v147, v147 row_shr:1 row_mask:0xf bank_mask:0xf bound_ctrl:0
    s_nop 0
    v_add_u32_dpp v146, v146, v146 row_shr:2 row_mask:0xf bank_mask:0xf bound_ctrl:0
    v_add_u32_dpp v147, v147, v147 row_shr:2 row_mask:0xf bank_mask:0xf bound_ctrl:0
    s_nop 0
    v_add_u32_dpp v146, v146, v146 row_shr:4 row_mask:0xf bank_mask:0xf bound_ctrl:0
    v_add_u32_dpp v147, v147, v147 row_shr:4 row_mask:0xf bank_mask:0xf bound_ctrl:0
    s_nop 0
    v_add_u32_dpp v146, v146, v146 row_shr:8 row_mask:0xf bank_mask:0xf bound_ctrl:0
    v_add_u32_dpp v147, v147, v147 row_shr:8 row_mask:0xf bank_mask:0xf bound_ctrl:0
    s_nop 0
    v_add_u32_dpp v146, v146, v146 row_bcast:15 row_mask:0xa bank_mask:0xf
    v_add_u32_dpp v147, v147, v147 row_bcast:15 row_mask:0xa bank_mask:0xf
    s_nop 0
    v_add_u32_dpp v146, v146, v146 row_bcast:31 row_mask:0xc bank_mask:0xf
    v_add_u32_dpp v147, v147, v147 row_bcast:31 row_mask:0xc bank_mask:0xf
    v_readlane_b32 s48, v146, 63
    v_readlane_b32 s49, v147, 63
    s_lshl_b32 s15, s4, 3
    s_add_u32 s15, s15, s12
    v_mov_b32 v150, s15
    v_mov_b32 v148, s48
    v_mov_b32 v149, s49
    ds_write_b64 v150, v[148:149] offset:4096
    s_waitcnt lgkmcnt(0)
P1_S1:
    s_barrier
    s_cmp_ge_u32 s4, 4
    s_cbranch_scc1 P1_S2
    v_and_b32 v148, 7, v0
    v_lshl_add_u32 v148, v148, 2, s12
    ds_read_b32 v148, v148 offset:4096
    v_sub_u32 v146, v146, v144
    v_sub_u32 v147, v147, v145
    s_waitcnt lgkmcnt(0)
    v_readlane_b32 s48, v148, 0
    v_readlane_b32 s49, v148, 1
    v_readlane_b32 s50, v148, 2
    v_readlane_b32 s51, v148, 3
    v_readlane_b32 s52, v148, 4
    v_readlane_b32 s53, v148, 5
    v_readlane_b32 s54, v148, 6
    v_readlane_b32 s55, v148, 7
    s_add_u32 s56, s48, s50
    s_add_u32 s56, s56, s52
    s_add_u32 s56, s56, s54
    s_add_u32 s57, s49, s51
    s_add_u32 s57, s57, s53
    s_add_u32 s57, s57, s55
    s_mov_b32 s58, 0
    s_mov_b32 s59, 0
    s_cmp_gt_u32 s4, 0
    s_cselect_b32 s48, s48, 0
    s_cselect_b32 s49, s49, 0
    s_add_u32 s58, s58, s48
    s_add_u32 s59, s59, s49
    s_cmp_gt_u32 s4, 1
    s_cselect_b32 s50, s50, 0
    s_cselect_b32 s51, s51, 0
    s_add_u32 s58, s58, s50
    s_add_u32 s59, s59, s51
    s_cmp_gt_u32 s4, 2
    s_cselect_b32 s52, s52, 0
    s_cselect_b32 s53, s53, 0
    s_add_u32 s58, s58, s52
    s_add_u32 s59, s59, s53
    s_add_u32 s64, s56, s57
    s_lshr_b32 s60, s64, 16
    s_and_b32 s64, s64, 0xffff
    s_add_u32 s64, s64, s60
    s_lshl_b32 s64, s64, 3
    s_and_b32 s48, s56, 0xffff
    s_lshr_b32 s49, s56, 16
    s_add_u32 s49, s49, s48
    s_and_b32 s50, s57, 0xffff
    s_add_u32 s50, s50, s49
    s_lshl_b32 s48, s48, 16
    s_add_u32 s58, s58, s48
    s_lshl_b32 s50, s50, 16
    s_add_u32 s59, s59, s49
    s_add_u32 s59, s59, s50
    v_add_u32 v146, s58, v146
    v_add_u32 v147, s59, v147
    v_and_b32 v148, 0xffff, v146
    v_lshrrev_b32 v149, 16, v146
    v_and_b32 v150, 0xffff, v147
    v_lshrrev_b32 v151, 16, v147
    v_lshl_or_b32 v140, v140, 16, v148
    v_lshl_or_b32 v141, v141, 16, v149
    v_lshl_or_b32 v142, v142, 16, v150
    v_lshl_or_b32 v143, v143, 16, v151
    ds_write_b128 v4, v[148:151]
    s_waitcnt lgkmcnt(0)
P1_S2:
    s_lshl_b32 s15, s3, 5
    buffer_store_dwordx4 v[140:143], v5, s[44:47], s15 offen
    s_barrier
    ds_read_b32 v100, v100
    ds_read_b32 v101, v101
    ds_read_b32 v102, v102
    ds_read_b32 v103, v103
    s_waitcnt lgkmcnt(0)
    v_add_lshl_u32 v100, v120, v100, 3
    ds_write_b64 v100, v[60:61]
    v_add_lshl_u32 v101, v121, v101, 3
    ds_write_b64 v101, v[62:63]
    v_add_lshl_u32 v102, v122, v102, 3
    ds_write_b64 v102, v[64:65]
    v_add_lshl_u32 v103, v123, v103, 3
    ds_write_b64 v103, v[66:67]
    ds_read_b32 v104, v104
    ds_read_b32 v105, v105
    ds_read_b32 v106, v106
    ds_read_b32 v107, v107
    s_waitcnt lgkmcnt(0)
    v_add_lshl_u32 v104, v124, v104, 3
    ds_write_b64 v104, v[68:69]
    v_add_lshl_u32 v105, v125, v105, 3
    ds_write_b64 v105, v[70:71]
    v_add_lshl_u32 v106, v126, v106, 3
    ds_write_b64 v106, v[72:73]
    v_add_lshl_u32 v107, v127, v107, 3
    ds_write_b64 v107, v[74:75]
    ds_read_b32 v108, v108
    ds_read_b32 v109, v109
    ds_read_b32 v110, v110
    ds_read_b32 v111, v111
    s_waitcnt lgkmcnt(0)
    v_add_lshl_u32 v108, v128, v108, 3
    ds_write_b64 v108, v[76:77]
    v_add_lshl_u32 v109, v129, v109, 3
    ds_write_b64 v109, v[78:79]
    v_add_lshl_u32 v110, v130, v110, 3
    ds_write_b64 v110, v[80:81]
    v_add_lshl_u32 v111, v131, v111, 3
    ds_write_b64 v111, v[82:83]
    ds_read_b32 v112, v112
    ds_read_b32 v113, v113
    ds_read_b32 v114, v114
    ds_read_b32 v115, v115
    s_waitcnt lgkmcnt(0)
    v_add_lshl_u32 v112, v132, v112, 3
    ds_write_b64 v112, v[84:85]
    v_add_lshl_u32 v113, v133, v113, 3
    ds_write_b64 v113, v[86:87]
    v_add_lshl_u32 v114, v134, v114, 3
    ds_write_b64 v114, v[88:89]
    v_add_lshl_u32 v115, v135, v115, 3
    ds_write_b64 v115, v[90:91]
    ds_read_b32 v116, v116
    ds_read_b32 v117, v117
    ds_read_b32 v118, v118
    ds_read_b32 v119, v119
    s_waitcnt lgkmcnt(0)
    v_add_lshl_u32 v116, v136, v116, 3
    ds_write_b64 v116, v[92:93]
    v_add_lshl_u32 v117, v137, v117, 3
    ds_write_b64 v117, v[94:95]
    v_add_lshl_u32 v118, v138, v118, 3
    ds_write_b64 v118, v[96:97]
    v_add_lshl_u32 v119, v139, v119, 3
    ds_write_b64 v119, v[98:99]
P1_SCAT_DONE:
    s_waitcnt lgkmcnt(0)
    s_barrier
    s_cmp_ge_u32 s4, 4
    s_cbranch_scc1 P1_Z1
    ds_write_b128 v4, v[6:9]
P1_Z1:
    s_mul_i32 s11, s3, 102400
    v_add_u32 v141, 61440, v2
    ds_read_b128 v[60:63], v2 offset:0
    ds_read_b128 v[64:67], v2 offset:10240
    ds_read_b128 v[68:71], v2 offset:20480
    ds_read_b128 v[72:75], v2 offset:30720
    ds_read_b128 v[76:79], v2 offset:40960
    ds_read_b128 v[80:83], v2 offset:51200
    ds_read_b128 v[84:87], v141 offset:0
    ds_read_b128 v[88:91], v141 offset:10240
    ds_read_b128 v[92:95], v141 offset:20480
    ds_read_b128 v[96:99], v141 offset:30720
    s_waitcnt lgkmcnt(9)
    buffer_store_dwordx4 v[60:63], v2, s[40:43], s11 offen
    s_add_u32 s11, s11, 10240
    s_waitcnt lgkmcnt(8)
    buffer_store_dwordx4 v[64:67], v2, s[40:43], s11 offen
    s_add_u32 s11, s11, 10240
    s_waitcnt lgkmcnt(7)
    buffer_store_dwordx4 v[68:71], v2, s[40:43], s11 offen
    s_add_u32 s11, s11, 10240
    s_waitcnt lgkmcnt(6)
    buffer_store_dwordx4 v[72:75], v2, s[40:43], s11 offen
    s_add_u32 s11, s11, 10240
    s_waitcnt lgkmcnt(5)
    buffer_store_dwordx4 v[76:79], v2, s[40:43], s11 offen
    s_add_u32 s11, s11, 10240
    s_waitcnt lgkmcnt(4)
    buffer_store_dwordx4 v[80:83], v2, s[40:43], s11 offen
    s_add_u32 s11, s11, 10240
    s_waitcnt lgkmcnt(3)
    buffer_store_dwordx4 v[84:87], v2, s[40:43], s11 offen
    s_add_u32 s11, s11, 10240
    s_waitcnt lgkmcnt(2)
    buffer_store_dwordx4 v[88:91], v2, s[40:43], s11 offen
    s_add_u32 s11, s11, 10240
    s_waitcnt lgkmcnt(1)
    buffer_store_dwordx4 v[92:95], v2, s[40:43], s11 offen
    s_add_u32 s11, s11, 10240
    s_waitcnt lgkmcnt(0)
    buffer_store_dwordx4 v[96:99], v2, s[40:43], s11 offen
    s_add_u32 s11, s11, 10240
    s_add_u32 s3, s3, 250
    s_cmp_lt_u32 s3, 500
    s_cbranch_scc1 P1_LOOP
P1_END:
    s_endpgm
.globl gp2_kernel
.p2align 8
.type gp2_kernel,@function
gp2_kernel:
    s_cmp_ge_u32 s2, 256
    s_cbranch_scc1 P2_END
    s_load_dwordx2 s[32:33], s[0:1], 104
    s_load_dwordx2 s[34:35], s[0:1], 24
    s_load_dwordx4 s[36:39], s[0:1], 80
    s_load_dwordx2 s[52:53], s[0:1], 0
    s_and_b32 s4, s2, 7
    s_lshl_b32 s4, s4, 5
    s_lshr_b32 s14, s2, 3
    s_add_u32 s4, s4, s14
    s_mov_b32 s3, 0xffff0000
    v_and_b32 v115, 63, v0
    v_lshrrev_b32 v92, 6, v0
    s_nop 0
    v_readfirstlane_b32 s5, v92
    v_mul_u32_u24 v94, 1, v115
    s_mul_i32 s14, s5, 32
    v_add_u32 v94, s14, v94
    s_lshr_b32 s14, s4, 1
    s_mul_i32 s14, s14, 16000
    s_and_b32 s15, s4, 1
    s_lshl_b32 s15, s15, 4
    s_add_u32 s14, s14, s15
    v_lshlrev_b32 v95, 5, v94
    s_mul_i32 s15, s4, 3136
    v_lshlrev_b32 v93, 1, v0
    v_lshlrev_b32 v12, 4, v0
    s_waitcnt lgkmcnt(0)
    s_add_u32 s24, s32, 0x6000000
    s_addc_u32 s25, s33, 0
    s_mov_b32 s26, 0x1f4000
    s_mov_b32 s27, 0x20000
    buffer_load_dwordx4 v[96:99], v95, s[24:27], s14 offen offset:0
    s_mov_b32 s28, s34
    s_mov_b32 s29, s35
    s_mov_b32 s30, 0xc3500
    s_mov_b32 s31, 0x20000
    buffer_load_ushort v14, v93, s[28:31], s15 offen
    buffer_load_ushort v15, v93, s[28:31], s15 offen offset:2048
    s_add_u32 s24, s32, 0x7600000
    s_addc_u32 s25, s33, 0
    s_mov_b32 s26, 0x2710
    s_mov_b32 s27, 0x20000
    buffer_load_dwordx4 v[52:55], v12, s[24:27], 0 offen
    s_add_u32 s24, s32, 0x7604000
    s_addc_u32 s25, s33, 0
    s_mov_b32 s26, 0x2710
    s_mov_b32 s27, 0x20000
    buffer_load_dwordx4 v[56:59], v12, s[24:27], 0 offen
    s_load_dwordx8 s[64:71], s[36:37], 0
    s_add_u32 s20, s32, 0x7000000
    s_addc_u32 s21, s33, 0
    s_mov_b32 s22, 0x30d400
    s_mov_b32 s23, 0x20000
    s_mov_b32 s16, s32
    s_mov_b32 s17, s33
    s_mov_b32 s18, 0x30d4000
    s_mov_b32 s19, 0x20000
    s_mov_b32 s44, s38
    s_mov_b32 s45, s39
    s_mov_b32 s46, 0x30d400
    s_mov_b32 s47, 0x20000
    s_mov_b32 s48, s52
    s_mov_b32 s49, s53
    s_mov_b32 s50, 0x30d400
    s_mov_b32 s51, 0x20000
    v_mov_b32 v108, 0
    v_mov_b32 v109, 0
    v_mov_b32 v110, 0
    v_mov_b32 v111, 0
    v_mov_b32 v18, 0
    v_mov_b32 v19, 0
    ds_write_b128 v12, v[108:111]
    v_cmp_gt_u32 vcc, 544, v0
    v_lshlrev_b32 v92, 2, v0
    v_add_u32 v92, 62976, v92
    ds_write_b32 v92, v18
    s_mov_b64 exec, vcc
    ds_write_b128 v12, v[108:111] offset:16384
    s_mov_b64 exec, -1
    v_lshlrev_b32 v3, 3, v115
    v_lshlrev_b32 v13, 3, v0
    v_add_u32 v13, 83456, v13
    s_mul_i32 s7, s5, 1024
    s_add_u32 s7, s7, 67072
    v_lshl_add_u32 v1, v115, 2, s7
    v_lshl_add_u32 v2, v115, 3, s7
    s_add_u32 s28, s32, 0x7800000
    s_addc_u32 s29, s33, 0
    s_mov_b32 s30, 0x280000
    s_mov_b32 s31, 0x20000
    s_waitcnt vmcnt(4)
    v_cmp_gt_u32 vcc, 500, v94
    v_cmp_gt_u32 s[42:43], 32, v115
    s_mov_b32 s14, 102400
    s_and_b64 vcc, vcc, s[42:43]
    v_mul_lo_u32 v112, v94, s14
    v_lshrrev_b32 v104, 16, v96
    v_and_b32 v96, 0xffff, v96
    v_cndmask_b32 v104, 0, v104, vcc
    v_lshl_add_u32 v8, v96, 3, v112
    v_lshrrev_b32 v105, 16, v97
    v_and_b32 v97, 0xffff, v97
    v_cndmask_b32 v105, 0, v105, vcc
    v_lshl_add_u32 v9, v97, 3, v112
    v_lshrrev_b32 v106, 16, v98
    v_and_b32 v98, 0xffff, v98
    v_cndmask_b32 v106, 0, v106, vcc
    v_lshl_add_u32 v10, v98, 3, v112
    v_lshrrev_b32 v107, 16, v99
    v_and_b32 v99, 0xffff, v99
    v_cndmask_b32 v107, 0, v107, vcc
    v_lshl_add_u32 v11, v99, 3, v112
    v_mov_b32 v96, v104
    v_mov_b32 v4, v96
    v_mov_b32 v97, v105
    v_mov_b32 v5, v97
    v_mov_b32 v98, v106
    v_mov_b32 v6, v98
    v_mov_b32 v99, v107
    v_mov_b32 v7, v99
    v_add_u32_dpp v4, v4, v4 row_shr:1 row_mask:0xf bank_mask:0xf bound_ctrl:0
    v_add_u32_dpp v5, v5, v5 row_shr:1 row_mask:0xf bank_mask:0xf bound_ctrl:0
    v_add_u32_dpp v6, v6, v6 row_shr:1 row_mask:0xf bank_mask:0xf bound_ctrl:0
    v_add_u32_dpp v7, v7, v7 row_shr:1 row_mask:0xf bank_mask:0xf bound_ctrl:0
    v_add_u32_dpp v4, v4, v4 row_shr:2 row_mask:0xf bank_mask:0xf bound_ctrl:0
    v_add_u32_dpp v5, v5, v5 row_shr:2 row_mask:0xf bank_mask:0xf bound_ctrl:0
    v_add_u32_dpp v6, v6, v6 row_shr:2 row_mask:0xf bank_mask:0xf bound_ctrl:0
    v_add_u32_dpp v7, v7, v7 row_shr:2 row_mask:0xf bank_mask:0xf bound_ctrl:0
    v_add_u32_dpp v4, v4, v4 row_shr:4 row_mask:0xf bank_mask:0xf bound_ctrl:0
    v_add_u32_dpp v5, v5, v5 row_shr:4 row_mask:0xf bank_mask:0xf bound_ctrl:0
    v_add_u32_dpp v6, v6, v6 row_shr:4 row_mask:0xf bank_mask:0xf bound_ctrl:0
    v_add_u32_dpp v7, v7, v7 row_shr:4 row_mask:0xf bank_mask:0xf bound_ctrl:0
    v_add_u32_dpp v4, v4, v4 row_shr:8 row_mask:0xf bank_mask:0xf bound_ctrl:0
    v_add_u32_dpp v5, v5, v5 row_shr:8 row_mask:0xf bank_mask:0xf bound_ctrl:0
    v_add_u32_dpp v6, v6, v6 row_shr:8 row_mask:0xf bank_mask:0xf bound_ctrl:0
    v_add_u32_dpp v7, v7, v7 row_shr:8 row_mask:0xf bank_mask:0xf bound_ctrl:0
    v_add_u32_dpp v4, v4, v4 row_bcast:15 row_mask:0xa bank_mask:0xf
    v_add_u32_dpp v5, v5, v5 row_bcast:15 row_mask:0xa bank_mask:0xf
    v_add_u32_dpp v6, v6, v6 row_bcast:15 row_mask:0xa bank_mask:0xf
    v_add_u32_dpp v7, v7, v7 row_bcast:15 row_mask:0xa bank_mask:0xf
    v_add_u32_dpp v4, v4, v4 row_bcast:31 row_mask:0xc bank_mask:0xf
    v_add_u32_dpp v5, v5, v5 row_bcast:31 row_mask:0xc bank_mask:0xf
    v_add_u32_dpp v6, v6, v6 row_bcast:31 row_mask:0xc bank_mask:0xf
    v_add_u32_dpp v7, v7, v7 row_bcast:31 row_mask:0xc bank_mask:0xf
    v_readlane_b32 s72, v4, 63
    v_readlane_b32 s73, v5, 63
    v_readlane_b32 s74, v6, 63
    v_readlane_b32 s75, v7, 63
    v_sub_u32 v4, v4, v96
    v_sub_u32 v5, v5, v97
    v_sub_u32 v6, v6, v98
    v_sub_u32 v7, v7, v99
    v_lshlrev_b32 v112, 3, v4
    v_cmp_ne_u32 vcc, 0, v104
    v_sub_u32 v8, v8, v112
    s_nop 0
    v_cndmask_b32 v4, -1, v4, vcc
    v_lshlrev_b32 v112, 3, v5
    v_cmp_ne_u32 vcc, 0, v105
    v_sub_u32 v9, v9, v112
    s_nop 0
    v_cndmask_b32 v5, -1, v5, vcc
    v_lshlrev_b32 v112, 3, v6
    v_cmp_ne_u32 vcc, 0, v106
    v_sub_u32 v10, v10, v112
    s_nop 0
    v_cndmask_b32 v6, -1, v6, vcc
    v_lshlrev_b32 v112, 3, v7
    v_cmp_ne_u32 vcc, 0, v107
    v_sub_u32 v11, v11, v112
    s_nop 0
    v_cndmask_b32 v7, -1, v7, vcc
    s_mov_b32 s8, 0
    s_mov_b32 s76, 0
    s_mov_b32 s80, 0
    s_mov_b32 s84, s72
    s_add_u32 s8, s8, s72
    s_mov_b32 s77, 0
    s_mov_b32 s81, 0
    s_mov_b32 s85, s73
    s_add_u32 s8, s8, s73
    s_mov_b32 s78, 0
    s_mov_b32 s82, 0
    s_mov_b32 s86, s74
    s_add_u32 s8, s8, s74
    s_mov_b32 s79, 0
    s_mov_b32 s83, 0
    s_mov_b32 s87, s75
    s_add_u32 s8, s8, s75
    ds_write_b64 v2, v[18:19] offset:0
    ds_write_b64 v2, v[18:19] offset:512
    s_add_u32 s15, s76, 0
    v_subrev_u32 v12, s15, v4
    v_cmp_gt_u32 vcc, 256, v12
    v_lshl_add_u32 v12, v12, 2, s7
    s_mov_b64 exec, vcc
    ds_write_b32 v12, v8
    s_mov_b64 exec, -1
    ds_read_b32 v36, v1 offset:0
    ds_read_b32 v38, v1 offset:256
    ds_read_b32 v40, v1 offset:512
    ds_read_b32 v42, v1 offset:768
    s_lshl_b32 s15, s15, 3
    s_waitcnt lgkmcnt(0)
    v_max_u32_dpp v36, v36, v36 row_shr:1 row_mask:0xf bank_mask:0xf bound_ctrl:0
    v_max_u32_dpp v38, v38, v38 row_shr:1 row_mask:0xf bank_mask:0xf bound_ctrl:0
    v_max_u32_dpp v40, v40, v40 row_shr:1 row_mask:0xf bank_mask:0xf bound_ctrl:0
    v_max_u32_dpp v42, v42, v42 row_shr:1 row_mask:0xf bank_mask:0xf bound_ctrl:0
    v_max_u32_dpp v36, v36, v36 row_shr:2 row_mask:0xf bank_mask:0xf bound_ctrl:0
    v_max_u32_dpp v38, v38, v38 row_shr:2 row_mask:0xf bank_mask:0xf bound_ctrl:0
    v_max_u32_dpp v40, v40, v40 row_shr:2 row_mask:0xf bank_mask:0xf bound_ctrl:0
    v_max_u32_dpp v42, v42, v42 row_shr:2 row_mask:0xf bank_mask:0xf bound_ctrl:0
    v_max_u32_dpp v36, v36, v36 row_shr:4 row_mask:0xf bank_mask:0xf bound_ctrl:0
    v_max_u32_dpp v38, v38, v38 row_shr:4 row_mask:0xf bank_mask:0xf bound_ctrl:0
    v_max_u32_dpp v40, v40, v40 row_shr:4 row_mask:0xf bank_mask:0xf bound_ctrl:0
    v_max_u32_dpp v42, v42, v42 row_shr:4 row_mask:0xf bank_mask:0xf bound_ctrl:0
    v_max_u32_dpp v36, v36, v36 row_shr:8 row_mask:0xf bank_mask:0xf bound_ctrl:0
    v_max_u32_dpp v38, v38, v38 row_shr:8 row_mask:0xf bank_mask:0xf bound_ctrl:0
    v_max_u32_dpp v40, v40, v40 row_shr:8 row_mask:0xf bank_mask:0xf bound_ctrl:0
    v_max_u32_dpp v42, v42, v42 row_shr:8 row_mask:0xf bank_mask:0xf bound_ctrl:0
    v_max_u32_dpp v36, v36, v36 row_bcast:15 row_mask:0xa bank_mask:0xf
    v_max_u32_dpp v38, v38, v38 row_bcast:15 row_mask:0xa bank_mask:0xf
    v_max_u32_dpp v40, v40, v40 row_bcast:15 row_mask:0xa bank_mask:0xf
    v_max_u32_dpp v42, v42, v42 row_bcast:15 row_mask:0xa bank_mask:0xf
    v_max_u32_dpp v36, v36, v36 row_bcast:31 row_mask:0xc bank_mask:0xf
    v_max_u32_dpp v38, v38, v38 row_bcast:31 row_mask:0xc bank_mask:0xf
    v_max_u32_dpp v40, v40, v40 row_bcast:31 row_mask:0xc bank_mask:0xf
    v_max_u32_dpp v42, v42, v42 row_bcast:31 row_mask:0xc bank_mask:0xf
    v_max_u32 v36, s80, v36
    s_nop 0
    v_readlane_b32 s80, v36, 63
    v_add3_u32 v36, v36, v3, s15
    s_add_u32 s15, s15, 512
    s_max_i32 s14, s84, 0
    s_bfm_b64 exec, s14, 0
    s_cmp_ge_i32 s14, 64
    s_cselect_b64 exec, -1, exec
    buffer_load_dwordx2 v[36:37], v36, s[16:19], 0 offen
    s_mov_b64 exec, -1
    v_max_u32 v38, s80, v38
    s_nop 0
    v_readlane_b32 s80, v38, 63
    v_add3_u32 v38, v38, v3, s15
    s_add_u32 s15, s15, 512
    s_sub_i32 s14, s84, 64
    s_max_i32 s14, s14, 0
    s_bfm_b64 exec, s14, 0
    s_cmp_ge_i32 s14, 64
    s_cselect_b64 exec, -1, exec
    buffer_load_dwordx2 v[38:39], v38, s[16:19], 0 offen
    s_mov_b64 exec, -1
    v_max_u32 v40, s80, v40
    s_nop 0
    v_readlane_b32 s80, v40, 63
    v_add3_u32 v40, v40, v3, s15
    s_add_u32 s15, s15, 512
    s_sub_i32 s14, s84, 128
    s_max_i32 s14, s14, 0
    s_bfm_b64 exec, s14, 0
    s_cmp_ge_i32 s14, 64
    s_cselect_b64 exec, -1, exec
    buffer_load_dwordx2 v[40:41], v40, s[16:19], 0 offen
    s_mov_b64 exec, -1
    v_max_u32 v42, s80, v42
    s_nop 0
    v_readlane_b32 s80, v42, 63
    v_add3_u32 v42, v42, v3, s15
    s_add_u32 s15, s15, 512
    s_sub_i32 s14, s84, 192
    s_max_i32 s14, s14, 0
    s_bfm_b64 exec, s14, 0
    s_cmp_ge_i32 s14, 64
    s_cselect_b64 exec, -1, exec
    buffer_load_dwordx2 v[42:43], v42, s[16:19], 0 offen
    s_mov_b64 exec, -1
    ds_write_b64 v2, v[18:19] offset:0
    s_add_u32 s15, s76, 256
    v_subrev_u32 v12, s15, v4
    v_cmp_gt_u32 vcc, 128, v12
    v_lshl_add_u32 v12, v12, 2, s7
    s_mov_b64 exec, vcc
    ds_write_b32 v12, v8
    s_mov_b64 exec, -1
    ds_read_b32 v44, v1 offset:0
    ds_read_b32 v46, v1 offset:256
    s_lshl_b32 s15, s15, 3
    s_waitcnt lgkmcnt(0)
    v_max_u32_dpp v44, v44, v44 row_shr:1 row_mask:0xf bank_mask:0xf bound_ctrl:0
    v_max_u32_dpp v46, v46, v46 row_shr:1 row_mask:0xf bank_mask:0xf bound_ctrl:0
    s_nop 0
    v_max_u32_dpp v44, v44, v44 row_shr:2 row_mask:0xf bank_mask:0xf bound_ctrl:0
    v_max_u32_dpp v46, v46, v46 row_shr:2 row_mask:0xf bank_mask:0xf bound_ctrl:0
    s_nop 0
    v_max_u32_dpp v44, v44, v44 row_shr:4 row_mask:0xf bank_mask:0xf bound_ctrl:0
    v_max_u32_dpp v46, v46, v46 row_shr:4 row_mask:0xf bank_mask:0xf bound_ctrl:0
    s_nop 0
    v_max_u32_dpp v44, v44, v44 row_shr:8 row_mask:0xf bank_mask:0xf bound_ctrl:0
    v_max_u32_dpp v46, v46, v46 row_shr:8 row_mask:0xf bank_mask:0xf bound_ctrl:0
    s_nop 0
    v_max_u32_dpp v44, v44, v44 row_bcast:15 row_mask:0xa bank_mask:0xf
    v_max_u32_dpp v46, v46, v46 row_bcast:15 row_mask:0xa bank_mask:0xf
    s_nop 0
    v_max_u32_dpp v44, v44, v44 row_bcast:31 row_mask:0xc bank_mask:0xf
    v_max_u32_dpp v46, v46, v46 row_bcast:31 row_mask:0xc bank_mask:0xf
    v_max_u32 v44, s80, v44
    s_nop 0
    v_readlane_b32 s80, v44, 63
    v_add3_u32 v44, v44, v3, s15
    s_add_u32 s15, s15, 512
    s_sub_i32 s14, s84, 256
    s_max_i32 s14, s14, 0
    s_bfm_b64 exec, s14, 0
    s_cmp_ge_i32 s14, 64
    s_cselect_b64 exec, -1, exec
    buffer_load_dwordx2 v[44:45], v44, s[16:19], 0 offen
    s_mov_b64 exec, -1
    v_max_u32 v46, s80, v46
    s_nop 0
    v_readlane_b32 s80, v46, 63
    v_add3_u32 v46, v46, v3, s15
    s_add_u32 s15, s15, 512
    s_sub_i32 s14, s84, 320
    s_max_i32 s14, s14, 0
    s_bfm_b64 exec, s14, 0
    s_cmp_ge_i32 s14, 64
    s_cselect_b64 exec, -1, exec
    buffer_load_dwordx2 v[46:47], v46, s[16:19], 0 offen
    s_mov_b64 exec, -1
    s_waitcnt vmcnt(9)
    v_lshlrev_b32 v112, 5, v14
    v_lshlrev_b32 v16, 3, v14
    buffer_load_dwordx4 v[96:99], v112, s[28:31], 0 offen
    buffer_load_dwordx4 v[104:107], v112, s[28:31], 0 offen offset:16
    s_waitcnt vmcnt(10)
    v_lshlrev_b32 v113, 5, v15
    v_lshlrev_b32 v17, 3, v15
    buffer_load_dwordx4 v[100:103], v113, s[28:31], 0 offen
    buffer_load_dwordx4 v[108:111], v113, s[28:31], 0 offen offset:16
    ds_write_b64 v2, v[18:19] offset:0
    ds_write_b64 v2, v[18:19] offset:512
    s_add_u32 s15, s77, 0
    v_subrev_u32 v12, s15, v5
    v_cmp_gt_u32 vcc, 256, v12
    v_lshl_add_u32 v12, v12, 2, s7
    s_mov_b64 exec, vcc
    ds_write_b32 v12, v9
    s_mov_b64 exec, -1
    ds_read_b32 v20, v1 offset:0
    ds_read_b32 v22, v1 offset:256
    ds_read_b32 v24, v1 offset:512
    ds_read_b32 v26, v1 offset:768
    s_lshl_b32 s15, s15, 3
    s_waitcnt lgkmcnt(0)
    v_max_u32_dpp v20, v20, v20 row_shr:1 row_mask:0xf bank_mask:0xf bound_ctrl:0
    v_max_u32_dpp v22, v22, v22 row_shr:1 row_mask:0xf bank_mask:0xf bound_ctrl:0
    v_max_u32_dpp v24, v24, v24 row_shr:1 row_mask:0xf bank_mask:0xf bound_ctrl:0
    v_max_u32_dpp v26, v26, v26 row_shr:1 row_mask:0xf bank_mask:0xf bound_ctrl:0
    v_max_u32_dpp v20, v20, v20 row_shr:2 row_mask:0xf bank_mask:0xf bound_ctrl:0
    v_max_u32_dpp v22, v22, v22 row_shr:2 row_mask:0xf bank_mask:0xf bound_ctrl:0
    v_max_u32_dpp v24, v24, v24 row_shr:2 row_mask:0xf bank_mask:0xf bound_ctrl:0
    v_max_u32_dpp v26, v26, v26 row_shr:2 row_mask:0xf bank_mask:0xf bound_ctrl:0
    v_max_u32_dpp v20, v20, v20 row_shr:4 row_mask:0xf bank_mask:0xf bound_ctrl:0
    v_max_u32_dpp v22, v22, v22 row_shr:4 row_mask:0xf bank_mask:0xf bound_ctrl:0
    v_max_u32_dpp v24, v24, v24 row_shr:4 row_mask:0xf bank_mask:0xf bound_ctrl:0
    v_max_u32_dpp v26, v26, v26 row_shr:4 row_mask:0xf bank_mask:0xf bound_ctrl:0
    v_max_u32_dpp v20, v20, v20 row_shr:8 row_mask:0xf bank_mask:0xf bound_ctrl:0
    v_max_u32_dpp v22, v22, v22 row_shr:8 row_mask:0xf bank_mask:0xf bound_ctrl:0
    v_max_u32_dpp v24, v24, v24 row_shr:8 row_mask:0xf bank_mask:0xf bound_ctrl:0
    v_max_u32_dpp v26, v26, v26 row_shr:8 row_mask:0xf bank_mask:0xf bound_ctrl:0
    v_max_u32_dpp v20, v20, v20 row_bcast:15 row_mask:0xa bank_mask:0xf
    v_max_u32_dpp v22, v22, v22 row_bcast:15 row_mask:0xa bank_mask:0xf
    v_max_u32_dpp v24, v24, v24 row_bcast:15 row_mask:0xa bank_mask:0xf
    v_max_u32_dpp v26, v26, v26 row_bcast:15 row_mask:0xa bank_mask:0xf
    v_max_u32_dpp v20, v20, v20 row_bcast:31 row_mask:0xc bank_mask:0xf
    v_max_u32_dpp v22, v22, v22 row_bcast:31 row_mask:0xc bank_mask:0xf
    v_max_u32_dpp v24, v24, v24 row_bcast:31 row_mask:0xc bank_mask:0xf
    v_max_u32_dpp v26, v26, v26 row_bcast:31 row_mask:0xc bank_mask:0xf
    v_max_u32 v20, s81, v20
    s_nop 0
    v_readlane_b32 s81, v20, 63
    v_add3_u32 v20, v20, v3, s15
    s_add_u32 s15, s15, 512
    s_max_i32 s14, s85, 0
    s_bfm_b64 exec, s14, 0
    s_cmp_ge_i32 s14, 64
    s_cselect_b64 exec, -1, exec
    buffer_load_dwordx2 v[20:21], v20, s[16:19], 0 offen
    s_mov_b64 exec, -1
    v_max_u32 v22, s81, v22
    s_nop 0
    v_readlane_b32 s81, v22, 63
    v_add3_u32 v22, v22, v3, s15
    s_add_u32 s15, s15, 512
    s_sub_i32 s14, s85, 64
    s_max_i32 s14, s14, 0
    s_bfm_b64 exec, s14, 0
    s_cmp_ge_i32 s14, 64
    s_cselect_b64 exec, -1, exec
    buffer_load_dwordx2 v[22:23], v22, s[16:19], 0 offen
    s_mov_b64 exec, -1
    v_max_u32 v24, s81, v24
    s_nop 0
    v_readlane_b32 s81, v24, 63
    v_add3_u32 v24, v24, v3, s15
    s_add_u32 s15, s15, 512
    s_sub_i32 s14, s85, 128
    s_max_i32 s14, s14, 0
    s_bfm_b64 exec, s14, 0
    s_cmp_ge_i32 s14, 64
    s_cselect_b64 exec, -1, exec
    buffer_load_dwordx2 v[24:25], v24, s[16:19], 0 offen
    s_mov_b64 exec, -1
    v_max_u32 v26, s81, v26
    s_nop 0
    v_readlane_b32 s81, v26, 63
    v_add3_u32 v26, v26, v3, s15
    s_add_u32 s15, s15, 512
    s_sub_i32 s14, s85, 192
    s_max_i32 s14, s14, 0
    s_bfm_b64 exec, s14, 0
    s_cmp_ge_i32 s14, 64
    s_cselect_b64 exec, -1, exec
    buffer_load_dwordx2 v[26:27], v26, s[16:19], 0 offen
    s_mov_b64 exec, -1
    ds_write_b64 v2, v[18:19] offset:0
    ds_write_b64 v2, v[18:19] offset:512
    s_add_u32 s15, s77, 256
    v_subrev_u32 v12, s15, v5
    v_cmp_gt_u32 vcc, 256, v12
    v_lshl_add_u32 v12, v12, 2, s7
    s_mov_b64 exec, vcc
    ds_write_b32 v12, v9
    s_mov_b64 exec, -1
    ds_read_b32 v28, v1 offset:0
    ds_read_b32 v30, v1 offset:256
    ds_read_b32 v32, v1 offset:512
    ds_read_b32 v34, v1 offset:768
    s_lshl_b32 s15, s15, 3
    s_waitcnt lgkmcnt(0)
    v_max_u32_dpp v28, v28, v28 row_shr:1 row_mask:0xf bank_mask:0xf bound_ctrl:0
    v_max_u32_dpp v30, v30, v30 row_shr:1 row_mask:0xf bank_mask:0xf bound_ctrl:0
    v_max_u32_dpp v32, v32, v32 row_shr:1 row_mask:0xf bank_mask:0xf bound_ctrl:0
    v_max_u32_dpp v34, v34, v34 row_shr:1 row_mask:0xf bank_mask:0xf bound_ctrl:0
    v_max_u32_dpp v28, v28, v28 row_shr:2 row_mask:0xf bank_mask:0xf bound_ctrl:0
    v_max_u32_dpp v30, v30, v30 row_shr:2 row_mask:0xf bank_mask:0xf bound_ctrl:0
    v_max_u32_dpp v32, v32, v32 row_shr:2 row_mask:0xf bank_mask:0xf bound_ctrl:0
    v_max_u32_dpp v34, v34, v34 row_shr:2 row_mask:0xf bank_mask:0xf bound_ctrl:0
    v_max_u32_dpp v28, v28, v28 row_shr:4 row_mask:0xf bank_mask:0xf bound_ctrl:0
    v_max_u32_dpp v30, v30, v30 row_shr:4 row_mask:0xf bank_mask:0xf bound_ctrl:0
    v_max_u32_dpp v32, v32, v32 row_shr:4 row_mask:0xf bank_mask:0xf bound_ctrl:0
    v_max_u32_dpp v34, v34, v34 row_shr:4 row_mask:0xf bank_mask:0xf bound_ctrl:0
    v_max_u32_dpp v28, v28, v28 row_shr:8 row_mask:0xf bank_mask:0xf bound_ctrl:0
    v_max_u32_dpp v30, v30, v30 row_shr:8 row_mask:0xf bank_mask:0xf bound_ctrl:0
    v_max_u32_dpp v32, v32, v32 row_shr:8 row_mask:0xf bank_mask:0xf bound_ctrl:0
    v_max_u32_dpp v34, v34, v34 row_shr:8 row_mask:0xf bank_mask:0xf bound_ctrl:0
    v_max_u32_dpp v28, v28, v28 row_bcast:15 row_mask:0xa bank_mask:0xf
    v_max_u32_dpp v30, v30, v30 row_bcast:15 row_mask:0xa bank_mask:0xf
    v_max_u32_dpp v32, v32, v32 row_bcast:15 row_mask:0xa bank_mask:0xf
    v_max_u32_dpp v34, v34, v34 row_bcast:15 row_mask:0xa bank_mask:0xf
    v_max_u32_dpp v28, v28, v28 row_bcast:31 row_mask:0xc bank_mask:0xf
    v_max_u32_dpp v30, v30, v30 row_bcast:31 row_mask:0xc bank_mask:0xf
    v_max_u32_dpp v32, v32, v32 row_bcast:31 row_mask:0xc bank_mask:0xf
    v_max_u32_dpp v34, v34, v34 row_bcast:31 row_mask:0xc bank_mask:0xf
    v_max_u32 v28, s81, v28
    s_nop 0
    v_readlane_b32 s81, v28, 63
    v_add3_u32 v28, v28, v3, s15
    s_add_u32 s15, s15, 512
    s_sub_i32 s14, s85, 256
    s_max_i32 s14, s14, 0
    s_bfm_b64 exec, s14, 0
    s_cmp_ge_i32 s14, 64
    s_cselect_b64 exec, -1, exec
    buffer_load_dwordx2 v[28:29], v28, s[16:19], 0 offen
    s_mov_b64 exec, -1
    v_max_u32 v30, s81, v30
    s_nop 0
    v_readlane_b32 s81, v30, 63
    v_add3_u32 v30, v30, v3, s15
    s_add_u32 s15, s15, 512
    s_sub_i32 s14, s85, 320
    s_max_i32 s14, s14, 0
    s_bfm_b64 exec, s14, 0
    s_cmp_ge_i32 s14, 64
    s_cselect_b64 exec, -1, exec
    buffer_load_dwordx2 v[30:31], v30, s[16:19], 0 offen
    s_mov_b64 exec, -1
    v_max_u32 v32, s81, v32
    s_nop 0
    v_readlane_b32 s81, v32, 63
    v_add3_u32 v32, v32, v3, s15
    s_add_u32 s15, s15, 512
    s_sub_i32 s14, s85, 384
    s_max_i32 s14, s14, 0
    s_bfm_b64 exec, s14, 0
    s_cmp_ge_i32 s14, 64
    s_cselect_b64 exec, -1, exec
    buffer_load_dwordx2 v[32:33], v32, s[16:19], 0 offen
    s_mov_b64 exec, -1
    v_max_u32 v34, s81, v34
    s_nop 0
    v_readlane_b32 s81, v34, 63
    v_add3_u32 v34, v34, v3, s15
    s_add_u32 s15, s15, 512
    s_sub_i32 s14, s85, 448
    s_max_i32 s14, s14, 0
    s_bfm_b64 exec, s14, 0
    s_cmp_ge_i32 s14, 64
    s_cselect_b64 exec, -1, exec
    buffer_load_dwordx2 v[34:35], v34, s[16:19], 0 offen
    s_mov_b64 exec, -1
    s_waitcnt vmcnt(17)
    s_max_i32 s14, s84, 0
    s_bfm_b64 exec, s14, 0
    s_cmp_ge_i32 s14, 64
    s_cselect_b64 exec, -1, exec
    v_mov_b32 v76, v37
    buffer_load_dwordx2 v[36:37], v36, s[20:23], 0 offen
    s_mov_b64 exec, -1
    v_max3_u32 v52, v52, v53, v54
    v_max_u32 v52, v52, v55
    v_add_f32 v56, v56, v57
    v_add_f32 v58, v58, v59
    v_add_f32 v56, v56, v58
    s_waitcnt vmcnt(9)
    v_cmp_gt_u32 vcc, 544, v0
    s_nop 1
    v_cndmask_b32 v111, 0, v111, vcc
    v_or_b32 v53, v107, v111
    v_lshlrev_b32 v53, 31, v53
    v_or_b32 v52, v52, v53
    s_nop 1
    v_max_u32_dpp v52, v52, v52 row_shr:1 row_mask:0xf bank_mask:0xf bound_ctrl:0
    s_nop 1
    v_max_u32_dpp v52, v52, v52 row_shr:2 row_mask:0xf bank_mask:0xf bound_ctrl:0
    s_nop 1
    v_max_u32_dpp v52, v52, v52 row_shr:4 row_mask:0xf bank_mask:0xf bound_ctrl:0
    s_nop 1
    v_max_u32_dpp v52, v52, v52 row_shr:8 row_mask:0xf bank_mask:0xf bound_ctrl:0
    s_nop 1
    v_max_u32_dpp v52, v52, v52 row_bcast:15 row_mask:0xa bank_mask:0xf
    s_nop 1
    v_max_u32_dpp v52, v52, v52 row_bcast:31 row_mask:0xc bank_mask:0xf
    v_add_f32_dpp v56, v56, v56 row_shr:1 row_mask:0xf bank_mask:0xf bound_ctrl:0
    s_nop 1
    v_add_f32_dpp v56, v56, v56 row_shr:2 row_mask:0xf bank_mask:0xf bound_ctrl:0
    s_nop 1
    v_add_f32_dpp v56, v56, v56 row_shr:4 row_mask:0xf bank_mask:0xf bound_ctrl:0
    s_nop 1
    v_add_f32_dpp v56, v56, v56 row_shr:8 row_mask:0xf bank_mask:0xf bound_ctrl:0
    s_nop 1
    v_add_f32_dpp v56, v56, v56 row_bcast:15 row_mask:0xa bank_mask:0xf
    s_nop 1
    v_add_f32_dpp v56, v56, v56 row_bcast:31 row_mask:0xc bank_mask:0xf
    v_readlane_b32 s14, v52, 63
    v_readlane_b32 s9, v56, 63
    s_lshl_b32 s15, s5, 3
    s_add_u32 s15, s15, 62720
    v_mov_b32 v52, s8
    v_mov_b32 v53, s14
    v_mov_b32 v54, s15
    v_mov_b32 v56, s9
    v_lshrrev_b32 v55, 1, v54
    s_mov_b64 exec, 1
    ds_write_b64 v54, v[52:53]
    ds_write_b32 v55, v56 offset:31552
    s_mov_b64 exec, -1
    s_waitcnt lgkmcnt(0)
    s_barrier
    v_and_b32 v54, 15, v0
    v_lshlrev_b32 v55, 2, v54
    v_lshlrev_b32 v54, 3, v54
    v_add_u32 v54, 62720, v54
    ds_read_b32 v56, v55 offset:62912
    ds_read_b64 v[52:53], v54
    s_pack_ll_b32_b16 s56, s64, s66
    s_pack_hh_b32_b16 s57, s64, s66
    s_pack_ll_b32_b16 s58, s65, s67
    s_pack_hh_b32_b16 s59, s65, s67
    s_pack_ll_b32_b16 s60, s68, s70
    s_pack_hh_b32_b16 s61, s68, s70
    s_pack_ll_b32_b16 s62, s69, s71
    s_pack_hh_b32_b16 s63, s69, s71
    s_waitcnt lgkmcnt(0)
    v_add_u32_dpp v52, v52, v52 row_shr:1 row_mask:0xf bank_mask:0xf bound_ctrl:0
    v_max_u32_dpp v53, v53, v53 row_shr:1 row_mask:0xf bank_mask:0xf bound_ctrl:0
    v_add_f32_dpp v56, v56, v56 row_shr:1 row_mask:0xf bank_mask:0xf bound_ctrl:0
    v_add_u32_dpp v52, v52, v52 row_shr:2 row_mask:0xf bank_mask:0xf bound_ctrl:0
    v_max_u32_dpp v53, v53, v53 row_shr:2 row_mask:0xf bank_mask:0xf bound_ctrl:0
    v_add_f32_dpp v56, v56, v56 row_shr:2 row_mask:0xf bank_mask:0xf bound_ctrl:0
    v_add_u32_dpp v52, v52, v52 row_shr:4 row_mask:0xf bank_mask:0xf bound_ctrl:0
    v_max_u32_dpp v53, v53, v53 row_shr:4 row_mask:0xf bank_mask:0xf bound_ctrl:0
    v_add_f32_dpp v56, v56, v56 row_shr:4 row_mask:0xf bank_mask:0xf bound_ctrl:0
    v_add_u32_dpp v52, v52, v52 row_shr:8 row_mask:0xf bank_mask:0xf bound_ctrl:0
    v_max_u32_dpp v53, v53, v53 row_shr:8 row_mask:0xf bank_mask:0xf bound_ctrl:0
    v_add_f32_dpp v56, v56, v56 row_shr:8 row_mask:0xf bank_mask:0xf bound_ctrl:0
    v_mul_f32 v56, 0x38a7c5ac, v56
    v_readlane_b32 s14, v52, 15
    v_readlane_b32 s15, v53, 15
    v_readlane_b32 s9, v56, 15
    s_or_b32 s14, s14, 1
    s_flbit_i32_b32 s14, s14
    s_sub_u32 s14, s14, 2
    s_min_u32 s14, s14, 22
    s_cmp_ge_u32 s15, 0x7f000000
    s_cselect_b32 s6, 1, 0
    s_cmp_gt_u32 s15, s9
    s_cselect_b32 s6, 1, s6
    s_cmp_lt_u32 s14, 12
    s_cselect_b32 s6, 1, s6
    s_lshr_b32 s15, s15, 23
    s_max_u32 s15, s15, 70
    s_min_u32 s15, s15, 190
    s_add_u32 s8, s14, 126
    s_sub_i32 s8, s8, s15
    s_cmp_lg_u32 s6, 0
    s_cselect_b32 s8, 0, s8
    s_add_u32 s9, s8, 127
    s_lshl_b32 s9, s9, 23
    v_lshlrev_b32 v112, 16, v96
    v_and_b32 v113, s3, v96
    v_mul_f32 v112, s9, v112
    v_mul_f32 v113, s9, v113
    v_cvt_pk_bf16_f32 v96, v112, v113
    v_lshlrev_b32 v112, 16, v97
    v_and_b32 v113, s3, v97
    v_mul_f32 v112, s9, v112
    v_mul_f32 v113, s9, v113
    v_cvt_pk_bf16_f32 v97, v112, v113
    v_lshlrev_b32 v112, 16, v98
    v_and_b32 v113, s3, v98
    v_mul_f32 v112, s9, v112
    v_mul_f32 v113, s9, v113
    v_cvt_pk_bf16_f32 v98, v112, v113
    v_lshlrev_b32 v112, 16, v99
    v_and_b32 v113, s3, v99
    v_mul_f32 v112, s9, v112
    v_mul_f32 v113, s9, v113
    v_cvt_pk_bf16_f32 v99, v112, v113
    v_lshlrev_b32 v112, 16, v104
    v_and_b32 v113, s3, v104
    v_mul_f32 v112, s9, v112
    v_mul_f32 v113, s9, v113
    v_cvt_pk_bf16_f32 v104, v112, v113
    v_lshlrev_b32 v112, 16, v105
    v_and_b32 v113, s3, v105
    v_mul_f32 v112, s9, v112
    v_mul_f32 v113, s9, v113
    v_cvt_pk_bf16_f32 v105, v112, v113
    v_mov_b32 v14, v106
    v_lshlrev_b32 v112, 16, v100
    v_and_b32 v113, s3, v100
    v_mul_f32 v112, s9, v112
    v_mul_f32 v113, s9, v113
    v_cvt_pk_bf16_f32 v100, v112, v113
    v_lshlrev_b32 v112, 16, v101
    v_and_b32 v113, s3, v101
    v_mul_f32 v112, s9, v112
    v_mul_f32 v113, s9, v113
    v_cvt_pk_bf16_f32 v101, v112, v113
    v_lshlrev_b32 v112, 16, v102
    v_and_b32 v113, s3, v102
    v_mul_f32 v112, s9, v112
    v_mul_f32 v113, s9, v113
    v_cvt_pk_bf16_f32 v102, v112, v113
    v_lshlrev_b32 v112, 16, v103
    v_and_b32 v113, s3, v103
    v_mul_f32 v112, s9, v112
    v_mul_f32 v113, s9, v113
    v_cvt_pk_bf16_f32 v103, v112, v113
    v_lshlrev_b32 v112, 16, v108
    v_and_b32 v113, s3, v108
    v_mul_f32 v112, s9, v112
    v_mul_f32 v113, s9, v113
    v_cvt_pk_bf16_f32 v108, v112, v113
    v_lshlrev_b32 v112, 16, v109
    v_and_b32 v113, s3, v109
    v_mul_f32 v112, s9, v112
    v_mul_f32 v113, s9, v113
    v_cvt_pk_bf16_f32 v109, v112, v113
    v_mov_b32 v15, v110
    v_lshlrev_b32 v92, 4, v0
    v_lshlrev_b32 v93, 3, v0
    ds_write_b128 v92, v[96:99] offset:37632
    ds_write_b64 v93, v[104:105] offset:25088
    v_cmp_gt_u32 vcc, 544, v0
    s_mov_b64 exec, vcc
    ds_write_b128 v92, v[100:103] offset:54016
    ds_write_b64 v93, v[108:109] offset:33280
    s_mov_b64 exec, -1
    v_mov_b32 v114, 1
    s_mov_b32 s42, 63840
    s_waitcnt vmcnt(8)
    s_max_i32 s14, s85, 0
    s_bfm_b64 exec, s14, 0
    s_cmp_ge_i32 s14, 64
    s_cselect_b64 exec, -1, exec
    v_lshrrev_b32 v12, 11, v20
    v_lshl_add_u32 v12, v12, 2, s42
    ds_add_rtn_u32 v68, v12, v114
    s_mov_b64 exec, -1
    s_waitcnt vmcnt(7)
    s_sub_i32 s14, s85, 64
    s_max_i32 s14, s14, 0
    s_bfm_b64 exec, s14, 0
    s_cmp_ge_i32 s14, 64
    s_cselect_b64 exec, -1, exec
    v_lshrrev_b32 v12, 11, v22
    v_lshl_add_u32 v12, v12, 2, s42
    ds_add_rtn_u32 v69, v12, v114
    s_mov_b64 exec, -1
    s_waitcnt vmcnt(6)
    s_sub_i32 s14, s85, 128
    s_max_i32 s14, s14, 0
    s_bfm_b64 exec, s14, 0
    s_cmp_ge_i32 s14, 64
    s_cselect_b64 exec, -1, exec
    v_lshrrev_b32 v12, 11, v24
    v_lshl_add_u32 v12, v12, 2, s42
    ds_add_rtn_u32 v70, v12, v114
    s_mov_b64 exec, -1
    s_waitcnt vmcnt(5)
    s_sub_i32 s14, s85, 192
    s_max_i32 s14, s14, 0
    s_bfm_b64 exec, s14, 0
    s_cmp_ge_i32 s14, 64
    s_cselect_b64 exec, -1, exec
    v_lshrrev_b32 v12, 11, v26
    v_lshl_add_u32 v12, v12, 2, s42
    ds_add_rtn_u32 v71, v12, v114
    s_mov_b64 exec, -1
    s_waitcnt vmcnt(4)
    s_sub_i32 s14, s85, 256
    s_max_i32 s14, s14, 0
    s_bfm_b64 exec, s14, 0
    s_cmp_ge_i32 s14, 64
    s_cselect_b64 exec, -1, exec
    v_lshrrev_b32 v12, 11, v28
    v_lshl_add_u32 v12, v12, 2, s42
    ds_add_rtn_u32 v72, v12, v114
    s_mov_b64 exec, -1
    s_waitcnt vmcnt(3)
    s_sub_i32 s14, s85, 320
    s_max_i32 s14, s14, 0
    s_bfm_b64 exec, s14, 0
    s_cmp_ge_i32 s14, 64
    s_cselect_b64 exec, -1, exec
    v_lshrrev_b32 v12, 11, v30
    v_lshl_add_u32 v12, v12, 2, s42
    ds_add_rtn_u32 v73, v12, v114
    s_mov_b64 exec, -1
    s_waitcnt vmcnt(2)
    s_sub_i32 s14, s85, 384
    s_max_i32 s14, s14, 0
    s_bfm_b64 exec, s14, 0
    s_cmp_ge_i32 s14, 64
    s_cselect_b64 exec, -1, exec
    v_lshrrev_b32 v12, 11, v32
    v_lshl_add_u32 v12, v12, 2, s42
    ds_add_rtn_u32 v74, v12, v114
    s_mov_b64 exec, -1
    s_waitcnt vmcnt(1)
    s_sub_i32 s14, s85, 448
    s_max_i32 s14, s14, 0
    s_bfm_b64 exec, s14, 0
    s_cmp_ge_i32 s14, 64
    s_cselect_b64 exec, -1, exec
    v_lshrrev_b32 v12, 11, v34
    v_lshl_add_u32 v12, v12, 2, s42
    ds_add_rtn_u32 v75, v12, v114
    s_mov_b64 exec, -1
    s_waitcnt lgkmcnt(0)
    s_sub_i32 s14, s84, 64
    s_max_i32 s14, s14, 0
    s_bfm_b64 exec, s14, 0
    s_cmp_ge_i32 s14, 64
    s_cselect_b64 exec, -1, exec
    v_mov_b32 v77, v39
    buffer_load_dwordx2 v[38:39], v38, s[20:23], 0 offen
    s_mov_b64 exec, -1
    s_waitcnt lgkmcnt(0)
    s_barrier
    s_cmp_lg_u32 s5, 15
    s_cbranch_scc1 P2_NS0
    v_lshlrev_b32 v102, 2, v3
    v_add_u32 v102, 65024, v102
    ds_read_b128 v[92:95], v102
    ds_read_b128 v[96:99], v102 offset:16
    s_waitcnt lgkmcnt(0)
    v_add_u32 v93, v93, v92
    v_add_u32 v94, v94, v93
    v_add_u32 v95, v95, v94
    v_add_u32 v96, v96, v95
    v_add_u32 v97, v97, v96
    v_add_u32 v98, v98, v97
    v_add_u32 v99, v99, v98
    v_mov_b32 v100, v99
    s_nop 1
    v_add_u32_dpp v100, v100, v100 row_shr:1 row_mask:0xf bank_mask:0xf bound_ctrl:0
    s_nop 1
    v_add_u32_dpp v100, v100, v100 row_shr:2 row_mask:0xf bank_mask:0xf bound_ctrl:0
    s_nop 1
    v_add_u32_dpp v100, v100, v100 row_shr:4 row_mask:0xf bank_mask:0xf bound_ctrl:0
    s_nop 1
    v_add_u32_dpp v100, v100, v100 row_shr:8 row_mask:0xf bank_mask:0xf bound_ctrl:0
    s_nop 1
    v_add_u32_dpp v100, v100, v100 row_bcast:15 row_mask:0xa bank_mask:0xf
    s_nop 1
    v_add_u32_dpp v100, v100, v100 row_bcast:31 row_mask:0xc bank_mask:0xf
    s_nop 0
    v_readlane_b32 s14, v100, 63
    v_sub_u32 v100, v100, v99
    v_add_u32 v99, v98, v100
    v_add_u32 v98, v97, v100
    v_add_u32 v97, v96, v100
    v_add_u32 v96, v95, v100
    v_add_u32 v95, v94, v100
    v_add_u32 v94, v93, v100
    v_add_u32 v93, v92, v100
    v_mov_b32 v92, v100
    ds_write_b128 v102, v[92:95]
    ds_write_b128 v102, v[96:99] offset:16
    v_mov_b32 v101, s14
    v_mov_b32 v103, 62852
    ds_write_b32 v103, v101
    s_waitcnt lgkmcnt(0)
P2_NS0:
    s_max_i32 s14, s84, 0
    s_bfm_b64 exec, s14, 0
    s_cmp_ge_i32 s14, 64
    s_cselect_b64 exec, -1, exec
    s_cbranch_execz P2_SK1
    v_and_b32 v94, 0xffff, v76
    v_add_u32 v93, v94, v94
    v_add_u32 v92, v93, v93
    ds_read_b64 v[104:105], v93 offset:25088
    ds_read_b128 v[100:103], v92 offset:37632
    v_and_b32 v95, s3, v76
    v_mul_f32 v96, 0.15915494, v95
    v_mul_f32 v97, 0x40400000, v95
    v_cos_f32 v96, v96
    v_cvt_pk_bf16_f32 v97, 0, v97
    v_mul_f32 v97, 0.15915494, v97
    v_mul_f32 v95, v96, v96
    v_cos_f32 v97, v97
    v_fma_f32 v95, v95, 2.0, -1.0
    v_cvt_pk_bf16_f32 v98, v96, v95
    v_cvt_pk_bf16_f32 v99, v97, 0
    v_cvt_pk_bf16_f32 v106, 0, v97
    s_waitcnt lgkmcnt(1)
    v_dot2_f32_bf16 v112, v104, v99, 0
    v_dot2_f32_bf16 v113, v104, v106, 0
    v_dot2_f32_bf16 v114, v105, v99, 0
    v_dot2_f32_bf16 v115, v105, v106, 0
    s_waitcnt lgkmcnt(0)
    v_dot2_f32_bf16 v112, v100, v98, v112
    v_dot2_f32_bf16 v113, v101, v98, v113
    v_dot2_f32_bf16 v114, v102, v98, v114
    v_dot2_f32_bf16 v115, v103, v98, v115
    s_waitcnt vmcnt(1)
    v_lshlrev_b32 v108, 16, v36
    v_and_b32 v109, s3, v36
    v_lshlrev_b32 v110, 16, v37
    v_and_b32 v111, s3, v37
    s_cmp_lg_u32 s6, 0
    v_mul_f32 v108, v108, v112
    v_mul_f32 v109, v109, v113
    v_mul_f32 v110, v110, v114
    v_mul_f32 v111, v111, v115
    s_cbranch_scc1 P2_FL1
    v_cvt_rpi_i32_f32 v112, v108
    ds_add_u32 v94, v112 offset:0
    v_cvt_rpi_i32_f32 v113, v109
    ds_add_u32 v94, v113 offset:6272
    v_cvt_rpi_i32_f32 v114, v110
    ds_add_u32 v94, v114 offset:12544
    v_cvt_rpi_i32_f32 v115, v111
    ds_add_u32 v94, v115 offset:18816
    s_branch P2_SK1
P2_FL1:
    ds_add_f32 v94, v108 offset:0
    ds_add_f32 v94, v109 offset:6272
    ds_add_f32 v94, v110 offset:12544
    ds_add_f32 v94, v111 offset:18816
P2_SK1:
    s_mov_b64 exec, -1
    s_waitcnt vmcnt(1)
    s_sub_i32 s14, s84, 128
    s_max_i32 s14, s14, 0
    s_bfm_b64 exec, s14, 0
    s_cmp_ge_i32 s14, 64
    s_cselect_b64 exec, -1, exec
    v_mov_b32 v78, v41
    buffer_load_dwordx2 v[40:41], v40, s[20:23], 0 offen
    s_mov_b64 exec, -1
    s_waitcnt lgkmcnt(0)
    s_barrier
    s_sub_i32 s14, s84, 64
    s_max_i32 s14, s14, 0
    s_bfm_b64 exec, s14, 0
    s_cmp_ge_i32 s14, 64
    s_cselect_b64 exec, -1, exec
    s_cbranch_execz P2_SK2
    v_and_b32 v94, 0xffff, v77
    v_add_u32 v93, v94, v94
    v_add_u32 v92, v93, v93
    ds_read_b64 v[104:105], v93 offset:25088
    ds_read_b128 v[100:103], v92 offset:37632
    v_and_b32 v95, s3, v77
    v_mul_f32 v96, 0.15915494, v95
    v_mul_f32 v97, 0x40400000, v95
    v_cos_f32 v96, v96
    v_cvt_pk_bf16_f32 v97, 0, v97
    v_mul_f32 v97, 0.15915494, v97
    v_mul_f32 v95, v96, v96
    v_cos_f32 v97, v97
    v_fma_f32 v95, v95, 2.0, -1.0
    v_cvt_pk_bf16_f32 v98, v96, v95
    v_cvt_pk_bf16_f32 v99, v97, 0
    v_cvt_pk_bf16_f32 v106, 0, v97
    s_waitcnt lgkmcnt(1)
    v_dot2_f32_bf16 v112, v104, v99, 0
    v_dot2_f32_bf16 v113, v104, v106, 0
    v_dot2_f32_bf16 v114, v105, v99, 0
    v_dot2_f32_bf16 v115, v105, v106, 0
    s_waitcnt lgkmcnt(0)
    v_dot2_f32_bf16 v112, v100, v98, v112
    v_dot2_f32_bf16 v113, v101, v98, v113
    v_dot2_f32_bf16 v114, v102, v98, v114
    v_dot2_f32_bf16 v115, v103, v98, v115
    s_waitcnt vmcnt(1)
    v_lshlrev_b32 v108, 16, v38
    v_and_b32 v109, s3, v38
    v_lshlrev_b32 v110, 16, v39
    v_and_b32 v111, s3, v39
    s_cmp_lg_u32 s6, 0
    v_mul_f32 v108, v108, v112
    v_mul_f32 v109, v109, v113
    v_mul_f32 v110, v110, v114
    v_mul_f32 v111, v111, v115
    s_cbranch_scc1 P2_FL2
    v_cvt_rpi_i32_f32 v112, v108
    ds_add_u32 v94, v112 offset:0
    v_cvt_rpi_i32_f32 v113, v109
    ds_add_u32 v94, v113 offset:6272
    v_cvt_rpi_i32_f32 v114, v110
    ds_add_u32 v94, v114 offset:12544
    v_cvt_rpi_i32_f32 v115, v111
    ds_add_u32 v94, v115 offset:18816
    s_branch P2_SK2
P2_FL2:
    ds_add_f32 v94, v108 offset:0
    ds_add_f32 v94, v109 offset:6272
    ds_add_f32 v94, v110 offset:12544
    ds_add_f32 v94, v111 offset:18816
P2_SK2:
    s_mov_b64 exec, -1
    s_waitcnt vmcnt(1)
    s_sub_i32 s14, s84, 192
    s_max_i32 s14, s14, 0
    s_bfm_b64 exec, s14, 0
    s_cmp_ge_i32 s14, 64
    s_cselect_b64 exec, -1, exec
    v_mov_b32 v79, v43
    buffer_load_dwordx2 v[42:43], v42, s[20:23], 0 offen
    s_mov_b64 exec, -1
    s_mov_b32 s42, 63840
    s_mov_b32 s43, 83456
    v_mov_b32 v100, 62852
    ds_read_b32 v100, v100
    v_lshrrev_b32 v102, 11, v20
    v_lshl_add_u32 v102, v102, 2, s42
    s_max_i32 s14, s85, 0
    s_bfm_b64 exec, s14, 0
    s_cmp_ge_i32 s14, 64
    s_cselect_b64 exec, -1, exec
    ds_read_b32 v102, v102
    s_mov_b64 exec, -1
    v_lshrrev_b32 v103, 11, v22
    v_lshl_add_u32 v103, v103, 2, s42
    s_sub_i32 s14, s85, 64
    s_max_i32 s14, s14, 0
    s_bfm_b64 exec, s14, 0
    s_cmp_ge_i32 s14, 64
    s_cselect_b64 exec, -1, exec
    ds_read_b32 v103, v103
    s_mov_b64 exec, -1
    v_lshrrev_b32 v104, 11, v24
    v_lshl_add_u32 v104, v104, 2, s42
    s_sub_i32 s14, s85, 128
    s_max_i32 s14, s14, 0
    s_bfm_b64 exec, s14, 0
    s_cmp_ge_i32 s14, 64
    s_cselect_b64 exec, -1, exec
    ds_read_b32 v104, v104
    s_mov_b64 exec, -1
    v_lshrrev_b32 v105, 11, v26
    v_lshl_add_u32 v105, v105, 2, s42
    s_sub_i32 s14, s85, 192
    s_max_i32 s14, s14, 0
    s_bfm_b64 exec, s14, 0
    s_cmp_ge_i32 s14, 64
    s_cselect_b64 exec, -1, exec
    ds_read_b32 v105, v105
    s_mov_b64 exec, -1
    v_lshrrev_b32 v106, 11, v28
    v_lshl_add_u32 v106, v106, 2, s42
    s_sub_i32 s14, s85, 256
    s_max_i32 s14, s14, 0
    s_bfm_b64 exec, s14, 0
    s_cmp_ge_i32 s14, 64
    s_cselect_b64 exec, -1, exec
    ds_read_b32 v106, v106
    s_mov_b64 exec, -1
    v_lshrrev_b32 v107, 11, v30
    v_lshl_add_u32 v107, v107, 2, s42
    s_sub_i32 s14, s85, 320
    s_max_i32 s14, s14, 0
    s_bfm_b64 exec, s14, 0
    s_cmp_ge_i32 s14, 64
    s_cselect_b64 exec, -1, exec
    ds_read_b32 v107, v107
    s_mov_b64 exec, -1
    v_lshrrev_b32 v108, 11, v32
    v_lshl_add_u32 v108, v108, 2, s42
    s_sub_i32 s14, s85, 384
    s_max_i32 s14, s14, 0
    s_bfm_b64 exec, s14, 0
    s_cmp_ge_i32 s14, 64
    s_cselect_b64 exec, -1, exec
    ds_read_b32 v108, v108
    s_mov_b64 exec, -1
    v_lshrrev_b32 v109, 11, v34
    v_lshl_add_u32 v109, v109, 2, s42
    s_sub_i32 s14, s85, 448
    s_max_i32 s14, s14, 0
    s_bfm_b64 exec, s14, 0
    s_cmp_ge_i32 s14, 64
    s_cselect_b64 exec, -1, exec
    ds_read_b32 v109, v109
    s_mov_b64 exec, -1
    s_waitcnt lgkmcnt(8)
    v_readfirstlane_b32 s89, v100
    s_lshl_b32 s15, s5, 6
    s_sub_i32 s89, s89, s15
    s_waitcnt lgkmcnt(7)
    v_add_u32 v102, v102, v68
    v_lshl_add_u32 v102, v102, 3, s43
    s_max_i32 s14, s85, 0
    s_bfm_b64 exec, s14, 0
    s_cmp_ge_i32 s14, 64
    s_cselect_b64 exec, -1, exec
    ds_write_b64 v102, v[20:21]
    s_mov_b64 exec, -1
    s_waitcnt lgkmcnt(7)
    v_add_u32 v103, v103, v69
    v_lshl_add_u32 v103, v103, 3, s43
    s_sub_i32 s14, s85, 64
    s_max_i32 s14, s14, 0
    s_bfm_b64 exec, s14, 0
    s_cmp_ge_i32 s14, 64
    s_cselect_b64 exec, -1, exec
    ds_write_b64 v103, v[22:23]
    s_mov_b64 exec, -1
    s_waitcnt lgkmcnt(7)
    v_add_u32 v104, v104, v70
    v_lshl_add_u32 v104, v104, 3, s43
    s_sub_i32 s14, s85, 128
    s_max_i32 s14, s14, 0
    s_bfm_b64 exec, s14, 0
    s_cmp_ge_i32 s14, 64
    s_cselect_b64 exec, -1, exec
    ds_write_b64 v104, v[24:25]
    s_mov_b64 exec, -1
    s_waitcnt lgkmcnt(7)
    v_add_u32 v105, v105, v71
    v_lshl_add_u32 v105, v105, 3, s43
    s_sub_i32 s14, s85, 192
    s_max_i32 s14, s14, 0
    s_bfm_b64 exec, s14, 0
    s_cmp_ge_i32 s14, 64
    s_cselect_b64 exec, -1, exec
    ds_write_b64 v105, v[26:27]
    s_mov_b64 exec, -1
    s_waitcnt lgkmcnt(7)
    v_add_u32 v106, v106, v72
    v_lshl_add_u32 v106, v106, 3, s43
    s_sub_i32 s14, s85, 256
    s_max_i32 s14, s14, 0
    s_bfm_b64 exec, s14, 0
    s_cmp_ge_i32 s14, 64
    s_cselect_b64 exec, -1, exec
    ds_write_b64 v106, v[28:29]
    s_mov_b64 exec, -1
    s_waitcnt lgkmcnt(7)
    v_add_u32 v107, v107, v73
    v_lshl_add_u32 v107, v107, 3, s43
    s_sub_i32 s14, s85, 320
    s_max_i32 s14, s14, 0
    s_bfm_b64 exec, s14, 0
    s_cmp_ge_i32 s14, 64
    s_cselect_b64 exec, -1, exec
    ds_write_b64 v107, v[30:31]
    s_mov_b64 exec, -1
    s_waitcnt lgkmcnt(7)
    v_add_u32 v108, v108, v74
    v_lshl_add_u32 v108, v108, 3, s43
    s_sub_i32 s14, s85, 384
    s_max_i32 s14, s14, 0
    s_bfm_b64 exec, s14, 0
    s_cmp_ge_i32 s14, 64
    s_cselect_b64 exec, -1, exec
    ds_write_b64 v108, v[32:33]
    s_mov_b64 exec, -1
    s_waitcnt lgkmcnt(7)
    v_add_u32 v109, v109, v75
    v_lshl_add_u32 v109, v109, 3, s43
    s_sub_i32 s14, s85, 448
    s_max_i32 s14, s14, 0
    s_bfm_b64 exec, s14, 0
    s_cmp_ge_i32 s14, 64
    s_cselect_b64 exec, -1, exec
    ds_write_b64 v109, v[34:35]
    s_mov_b64 exec, -1
    s_waitcnt lgkmcnt(0)
    s_sub_i32 s14, s84, 128
    s_max_i32 s14, s14, 0
    s_bfm_b64 exec, s14, 0
    s_cmp_ge_i32 s14, 64
    s_cselect_b64 exec, -1, exec
    s_cbranch_execz P2_SK3
    v_and_b32 v94, 0xffff, v78
    v_add_u32 v93, v94, v94
    v_add_u32 v92, v93, v93
    ds_read_b64 v[104:105], v93 offset:25088
    ds_read_b128 v[100:103], v92 offset:37632
    v_and_b32 v95, s3, v78
    v_mul_f32 v96, 0.15915494, v95
    v_mul_f32 v97, 0x40400000, v95
    v_cos_f32 v96, v96
    v_cvt_pk_bf16_f32 v97, 0, v97
    v_mul_f32 v97, 0.15915494, v97
    v_mul_f32 v95, v96, v96
    v_cos_f32 v97, v97
    v_fma_f32 v95, v95, 2.0, -1.0
    v_cvt_pk_bf16_f32 v98, v96, v95
    v_cvt_pk_bf16_f32 v99, v97, 0
    v_cvt_pk_bf16_f32 v106, 0, v97
    s_waitcnt lgkmcnt(1)
    v_dot2_f32_bf16 v112, v104, v99, 0
    v_dot2_f32_bf16 v113, v104, v106, 0
    v_dot2_f32_bf16 v114, v105, v99, 0
    v_dot2_f32_bf16 v115, v105, v106, 0
    s_waitcnt lgkmcnt(0)
    v_dot2_f32_bf16 v112, v100, v98, v112
    v_dot2_f32_bf16 v113, v101, v98, v113
    v_dot2_f32_bf16 v114, v102, v98, v114
    v_dot2_f32_bf16 v115, v103, v98, v115
    s_waitcnt vmcnt(1)
    v_lshlrev_b32 v108, 16, v40
    v_and_b32 v109, s3, v40
    v_lshlrev_b32 v110, 16, v41
    v_and_b32 v111, s3, v41
    s_cmp_lg_u32 s6, 0
    v_mul_f32 v108, v108, v112
    v_mul_f32 v109, v109, v113
    v_mul_f32 v110, v110, v114
    v_mul_f32 v111, v111, v115
    s_cbranch_scc1 P2_FL3
    v_cvt_rpi_i32_f32 v112, v108
    ds_add_u32 v94, v112 offset:0
    v_cvt_rpi_i32_f32 v113, v109
    ds_add_u32 v94, v113 offset:6272
    v_cvt_rpi_i32_f32 v114, v110
    ds_add_u32 v94, v114 offset:12544
    v_cvt_rpi_i32_f32 v115, v111
    ds_add_u32 v94, v115 offset:18816
    s_branch P2_SK3
P2_FL3:
    ds_add_f32 v94, v108 offset:0
    ds_add_f32 v94, v109 offset:6272
    ds_add_f32 v94, v110 offset:12544
    ds_add_f32 v94, v111 offset:18816
P2_SK3:
    s_mov_b64 exec, -1
    s_waitcnt vmcnt(1)
    s_sub_i32 s14, s84, 256
    s_max_i32 s14, s14, 0
    s_bfm_b64 exec, s14, 0
    s_cmp_ge_i32 s14, 64
    s_cselect_b64 exec, -1, exec
    v_mov_b32 v80, v45
    buffer_load_dwordx2 v[44:45], v44, s[20:23], 0 offen
    s_mov_b64 exec, -1
    ds_write_b64 v2, v[18:19] offset:0
    ds_write_b64 v2, v[18:19] offset:512
    s_add_u32 s15, s78, 0
    v_subrev_u32 v12, s15, v6
    v_cmp_gt_u32 vcc, 256, v12
    v_lshl_add_u32 v12, v12, 2, s7
    s_mov_b64 exec, vcc
    ds_write_b32 v12, v10
    s_mov_b64 exec, -1
    ds_read_b32 v20, v1 offset:0
    ds_read_b32 v22, v1 offset:256
    ds_read_b32 v24, v1 offset:512
    ds_read_b32 v26, v1 offset:768
    s_lshl_b32 s15, s15, 3
    s_waitcnt lgkmcnt(0)
    v_max_u32_dpp v20, v20, v20 row_shr:1 row_mask:0xf bank_mask:0xf bound_ctrl:0
    v_max_u32_dpp v22, v22, v22 row_shr:1 row_mask:0xf bank_mask:0xf bound_ctrl:0
    v_max_u32_dpp v24, v24, v24 row_shr:1 row_mask:0xf bank_mask:0xf bound_ctrl:0
    v_max_u32_dpp v26, v26, v26 row_shr:1 row_mask:0xf bank_mask:0xf bound_ctrl:0
    v_max_u32_dpp v20, v20, v20 row_shr:2 row_mask:0xf bank_mask:0xf bound_ctrl:0
    v_max_u32_dpp v22, v22, v22 row_shr:2 row_mask:0xf bank_mask:0xf bound_ctrl:0
    v_max_u32_dpp v24, v24, v24 row_shr:2 row_mask:0xf bank_mask:0xf bound_ctrl:0
    v_max_u32_dpp v26, v26, v26 row_shr:2 row_mask:0xf bank_mask:0xf bound_ctrl:0
    v_max_u32_dpp v20, v20, v20 row_shr:4 row_mask:0xf bank_mask:0xf bound_ctrl:0
    v_max_u32_dpp v22, v22, v22 row_shr:4 row_mask:0xf bank_mask:0xf bound_ctrl:0
    v_max_u32_dpp v24, v24, v24 row_shr:4 row_mask:0xf bank_mask:0xf bound_ctrl:0
    v_max_u32_dpp v26, v26, v26 row_shr:4 row_mask:0xf bank_mask:0xf bound_ctrl:0
    v_max_u32_dpp v20, v20, v20 row_shr:8 row_mask:0xf bank_mask:0xf bound_ctrl:0
    v_max_u32_dpp v22, v22, v22 row_shr:8 row_mask:0xf bank_mask:0xf bound_ctrl:0
    v_max_u32_dpp v24, v24, v24 row_shr:8 row_mask:0xf bank_mask:0xf bound_ctrl:0
    v_max_u32_dpp v26, v26, v26 row_shr:8 row_mask:0xf bank_mask:0xf bound_ctrl:0
    v_max_u32_dpp v20, v20, v20 row_bcast:15 row_mask:0xa bank_mask:0xf
    v_max_u32_dpp v22, v22, v22 row_bcast:15 row_mask:0xa bank_mask:0xf
    v_max_u32_dpp v24, v24, v24 row_bcast:15 row_mask:0xa bank_mask:0xf
    v_max_u32_dpp v26, v26, v26 row_bcast:15 row_mask:0xa bank_mask:0xf
    v_max_u32_dpp v20, v20, v20 row_bcast:31 row_mask:0xc bank_mask:0xf
    v_max_u32_dpp v22, v22, v22 row_bcast:31 row_mask:0xc bank_mask:0xf
    v_max_u32_dpp v24, v24, v24 row_bcast:31 row_mask:0xc bank_mask:0xf
    v_max_u32_dpp v26, v26, v26 row_bcast:31 row_mask:0xc bank_mask:0xf
    v_max_u32 v20, s82, v20
    s_nop 0
    v_readlane_b32 s82, v20, 63
    v_add3_u32 v20, v20, v3, s15
    s_add_u32 s15, s15, 512
    s_max_i32 s14, s86, 0
    s_bfm_b64 exec, s14, 0
    s_cmp_ge_i32 s14, 64
    s_cselect_b64 exec, -1, exec
    buffer_load_dwordx2 v[20:21], v20, s[16:19], 0 offen
    s_mov_b64 exec, -1
    v_max_u32 v22, s82, v22
    s_nop 0
    v_readlane_b32 s82, v22, 63
    v_add3_u32 v22, v22, v3, s15
    s_add_u32 s15, s15, 512
    s_sub_i32 s14, s86, 64
    s_max_i32 s14, s14, 0
    s_bfm_b64 exec, s14, 0
    s_cmp_ge_i32 s14, 64
    s_cselect_b64 exec, -1, exec
    buffer_load_dwordx2 v[22:23], v22, s[16:19], 0 offen
    s_mov_b64 exec, -1
    v_max_u32 v24, s82, v24
    s_nop 0
    v_readlane_b32 s82, v24, 63
    v_add3_u32 v24, v24, v3, s15
    s_add_u32 s15, s15, 512
    s_sub_i32 s14, s86, 128
    s_max_i32 s14, s14, 0
    s_bfm_b64 exec, s14, 0
    s_cmp_ge_i32 s14, 64
    s_cselect_b64 exec, -1, exec
    buffer_load_dwordx2 v[24:25], v24, s[16:19], 0 offen
    s_mov_b64 exec, -1
    v_max_u32 v26, s82, v26
    s_nop 0
    v_readlane_b32 s82, v26, 63
    v_add3_u32 v26, v26, v3, s15
    s_add_u32 s15, s15, 512
    s_sub_i32 s14, s86, 192
    s_max_i32 s14, s14, 0
    s_bfm_b64 exec, s14, 0
    s_cmp_ge_i32 s14, 64
    s_cselect_b64 exec, -1, exec
    buffer_load_dwordx2 v[26:27], v26, s[16:19], 0 offen
    s_mov_b64 exec, -1
    ds_write_b64 v2, v[18:19] offset:0
    ds_write_b64 v2, v[18:19] offset:512
    s_add_u32 s15, s78, 256
    v_subrev_u32 v12, s15, v6
    v_cmp_gt_u32 vcc, 256, v12
    v_lshl_add_u32 v12, v12, 2, s7
    s_mov_b64 exec, vcc
    ds_write_b32 v12, v10
    s_mov_b64 exec, -1
    ds_read_b32 v28, v1 offset:0
    ds_read_b32 v30, v1 offset:256
    ds_read_b32 v32, v1 offset:512
    ds_read_b32 v34, v1 offset:768
    s_lshl_b32 s15, s15, 3
    s_waitcnt lgkmcnt(0)
    v_max_u32_dpp v28, v28, v28 row_shr:1 row_mask:0xf bank_mask:0xf bound_ctrl:0
    v_max_u32_dpp v30, v30, v30 row_shr:1 row_mask:0xf bank_mask:0xf bound_ctrl:0
    v_max_u32_dpp v32, v32, v32 row_shr:1 row_mask:0xf bank_mask:0xf bound_ctrl:0
    v_max_u32_dpp v34, v34, v34 row_shr:1 row_mask:0xf bank_mask:0xf bound_ctrl:0
    v_max_u32_dpp v28, v28, v28 row_shr:2 row_mask:0xf bank_mask:0xf bound_ctrl:0
    v_max_u32_dpp v30, v30, v30 row_shr:2 row_mask:0xf bank_mask:0xf bound_ctrl:0
    v_max_u32_dpp v32, v32, v32 row_shr:2 row_mask:0xf bank_mask:0xf bound_ctrl:0
    v_max_u32_dpp v34, v34, v34 row_shr:2 row_mask:0xf bank_mask:0xf bound_ctrl:0
    v_max_u32_dpp v28, v28, v28 row_shr:4 row_mask:0xf bank_mask:0xf bound_ctrl:0
    v_max_u32_dpp v30, v30, v30 row_shr:4 row_mask:0xf bank_mask:0xf bound_ctrl:0
    v_max_u32_dpp v32, v32, v32 row_shr:4 row_mask:0xf bank_mask:0xf bound_ctrl:0
    v_max_u32_dpp v34, v34, v34 row_shr:4 row_mask:0xf bank_mask:0xf bound_ctrl:0
    v_max_u32_dpp v28, v28, v28 row_shr:8 row_mask:0xf bank_mask:0xf bound_ctrl:0
    v_max_u32_dpp v30, v30, v30 row_shr:8 row_mask:0xf bank_mask:0xf bound_ctrl:0
    v_max_u32_dpp v32, v32, v32 row_shr:8 row_mask:0xf bank_mask:0xf bound_ctrl:0
    v_max_u32_dpp v34, v34, v34 row_shr:8 row_mask:0xf bank_mask:0xf bound_ctrl:0
    v_max_u32_dpp v28, v28, v28 row_bcast:15 row_mask:0xa bank_mask:0xf
    v_max_u32_dpp v30, v30, v30 row_bcast:15 row_mask:0xa bank_mask:0xf
    v_max_u32_dpp v32, v32, v32 row_bcast:15 row_mask:0xa bank_mask:0xf
    v_max_u32_dpp v34, v34, v34 row_bcast:15 row_mask:0xa bank_mask:0xf
    v_max_u32_dpp v28, v28, v28 row_bcast:31 row_mask:0xc bank_mask:0xf
    v_max_u32_dpp v30, v30, v30 row_bcast:31 row_mask:0xc bank_mask:0xf
    v_max_u32_dpp v32, v32, v32 row_bcast:31 row_mask:0xc bank_mask:0xf
    v_max_u32_dpp v34, v34, v34 row_bcast:31 row_mask:0xc bank_mask:0xf
    v_max_u32 v28, s82, v28
    s_nop 0
    v_readlane_b32 s82, v28, 63
    v_add3_u32 v28, v28, v3, s15
    s_add_u32 s15, s15, 512
    s_sub_i32 s14, s86, 256
    s_max_i32 s14, s14, 0
    s_bfm_b64 exec, s14, 0
    s_cmp_ge_i32 s14, 64
    s_cselect_b64 exec, -1, exec
    buffer_load_dwordx2 v[28:29], v28, s[16:19], 0 offen
    s_mov_b64 exec, -1
    v_max_u32 v30, s82, v30
    s_nop 0
    v_readlane_b32 s82, v30, 63
    v_add3_u32 v30, v30, v3, s15
    s_add_u32 s15, s15, 512
    s_sub_i32 s14, s86, 320
    s_max_i32 s14, s14, 0
    s_bfm_b64 exec, s14, 0
    s_cmp_ge_i32 s14, 64
    s_cselect_b64 exec, -1, exec
    buffer_load_dwordx2 v[30:31], v30, s[16:19], 0 offen
    s_mov_b64 exec, -1
    v_max_u32 v32, s82, v32
    s_nop 0
    v_readlane_b32 s82, v32, 63
    v_add3_u32 v32, v32, v3, s15
    s_add_u32 s15, s15, 512
    s_sub_i32 s14, s86, 384
    s_max_i32 s14, s14, 0
    s_bfm_b64 exec, s14, 0
    s_cmp_ge_i32 s14, 64
    s_cselect_b64 exec, -1, exec
    buffer_load_dwordx2 v[32:33], v32, s[16:19], 0 offen
    s_mov_b64 exec, -1
    v_max_u32 v34, s82, v34
    s_nop 0
    v_readlane_b32 s82, v34, 63
    v_add3_u32 v34, v34, v3, s15
    s_add_u32 s15, s15, 512
    s_sub_i32 s14, s86, 448
    s_max_i32 s14, s14, 0
    s_bfm_b64 exec, s14, 0
    s_cmp_ge_i32 s14, 64
    s_cselect_b64 exec, -1, exec
    buffer_load_dwordx2 v[34:35], v34, s[16:19], 0 offen
    s_mov_b64 exec, -1
    s_sub_i32 s14, s84, 192
    s_max_i32 s14, s14, 0
    s_bfm_b64 exec, s14, 0
    s_cmp_ge_i32 s14, 64
    s_cselect_b64 exec, -1, exec
    s_cbranch_execz P2_SK4
    v_and_b32 v94, 0xffff, v79
    v_add_u32 v93, v94, v94
    v_add_u32 v92, v93, v93
    ds_read_b64 v[104:105], v93 offset:25088
    ds_read_b128 v[100:103], v92 offset:37632
    v_and_b32 v95, s3, v79
    v_mul_f32 v96, 0.15915494, v95
    v_mul_f32 v97, 0x40400000, v95
    v_cos_f32 v96, v96
    v_cvt_pk_bf16_f32 v97, 0, v97
    v_mul_f32 v97, 0.15915494, v97
    v_mul_f32 v95, v96, v96
    v_cos_f32 v97, v97
    v_fma_f32 v95, v95, 2.0, -1.0
    v_cvt_pk_bf16_f32 v98, v96, v95
    v_cvt_pk_bf16_f32 v99, v97, 0
    v_cvt_pk_bf16_f32 v106, 0, v97
    s_waitcnt lgkmcnt(1)
    v_dot2_f32_bf16 v112, v104, v99, 0
    v_dot2_f32_bf16 v113, v104, v106, 0
    v_dot2_f32_bf16 v114, v105, v99, 0
    v_dot2_f32_bf16 v115, v105, v106, 0
    s_waitcnt lgkmcnt(0)
    v_dot2_f32_bf16 v112, v100, v98, v112
    v_dot2_f32_bf16 v113, v101, v98, v113
    v_dot2_f32_bf16 v114, v102, v98, v114
    v_dot2_f32_bf16 v115, v103, v98, v115
    s_waitcnt vmcnt(9)
    v_lshlrev_b32 v108, 16, v42
    v_and_b32 v109, s3, v42
    v_lshlrev_b32 v110, 16, v43
    v_and_b32 v111, s3, v43
    s_cmp_lg_u32 s6, 0
    v_mul_f32 v108, v108, v112
    v_mul_f32 v109, v109, v113
    v_mul_f32 v110, v110, v114
    v_mul_f32 v111, v111, v115
    s_cbranch_scc1 P2_FL4
    v_cvt_rpi_i32_f32 v112, v108
    ds_add_u32 v94, v112 offset:0
    v_cvt_rpi_i32_f32 v113, v109
    ds_add_u32 v94, v113 offset:6272
    v_cvt_rpi_i32_f32 v114, v110
    ds_add_u32 v94, v114 offset:12544
    v_cvt_rpi_i32_f32 v115, v111
    ds_add_u32 v94, v115 offset:18816
    s_branch P2_SK4
P2_FL4:
    ds_add_f32 v94, v108 offset:0
    ds_add_f32 v94, v109 offset:6272
    ds_add_f32 v94, v110 offset:12544
    ds_add_f32 v94, v111 offset:18816
P2_SK4:
    s_mov_b64 exec, -1
    s_waitcnt vmcnt(9)
    s_sub_i32 s14, s84, 320
    s_max_i32 s14, s14, 0
    s_bfm_b64 exec, s14, 0
    s_cmp_ge_i32 s14, 64
    s_cselect_b64 exec, -1, exec
    v_mov_b32 v81, v47
    buffer_load_dwordx2 v[46:47], v46, s[20:23], 0 offen
    s_mov_b64 exec, -1
    s_sub_i32 s14, s84, 256
    s_max_i32 s14, s14, 0
    s_bfm_b64 exec, s14, 0
    s_cmp_ge_i32 s14, 64
    s_cselect_b64 exec, -1, exec
    s_cbranch_execz P2_SK5
    v_and_b32 v94, 0xffff, v80
    v_add_u32 v93, v94, v94
    v_add_u32 v92, v93, v93
    ds_read_b64 v[104:105], v93 offset:25088
    ds_read_b128 v[100:103], v92 offset:37632
    v_and_b32 v95, s3, v80
    v_mul_f32 v96, 0.15915494, v95
    v_mul_f32 v97, 0x40400000, v95
    v_cos_f32 v96, v96
    v_cvt_pk_bf16_f32 v97, 0, v97
    v_mul_f32 v97, 0.15915494, v97
    v_mul_f32 v95, v96, v96
    v_cos_f32 v97, v97
    v_fma_f32 v95, v95, 2.0, -1.0
    v_cvt_pk_bf16_f32 v98, v96, v95
    v_cvt_pk_bf16_f32 v99, v97, 0
    v_cvt_pk_bf16_f32 v106, 0, v97
    s_waitcnt lgkmcnt(1)
    v_dot2_f32_bf16 v112, v104, v99, 0
    v_dot2_f32_bf16 v113, v104, v106, 0
    v_dot2_f32_bf16 v114, v105, v99, 0
    v_dot2_f32_bf16 v115, v105, v106, 0
    s_waitcnt lgkmcnt(0)
    v_dot2_f32_bf16 v112, v100, v98, v112
    v_dot2_f32_bf16 v113, v101, v98, v113
    v_dot2_f32_bf16 v114, v102, v98, v114
    v_dot2_f32_bf16 v115, v103, v98, v115
    s_waitcnt vmcnt(9)
    v_lshlrev_b32 v108, 16, v44
    v_and_b32 v109, s3, v44
    v_lshlrev_b32 v110, 16, v45
    v_and_b32 v111, s3, v45
    s_cmp_lg_u32 s6, 0
    v_mul_f32 v108, v108, v112
    v_mul_f32 v109, v109, v113
    v_mul_f32 v110, v110, v114
    v_mul_f32 v111, v111, v115
    s_cbranch_scc1 P2_FL5
    v_cvt_rpi_i32_f32 v112, v108
    ds_add_u32 v94, v112 offset:0
    v_cvt_rpi_i32_f32 v113, v109
    ds_add_u32 v94, v113 offset:6272
    v_cvt_rpi_i32_f32 v114, v110
    ds_add_u32 v94, v114 offset:12544
    v_cvt_rpi_i32_f32 v115, v111
    ds_add_u32 v94, v115 offset:18816
    s_branch P2_SK5
P2_FL5:
    ds_add_f32 v94, v108 offset:0
    ds_add_f32 v94, v109 offset:6272
    ds_add_f32 v94, v110 offset:12544
    ds_add_f32 v94, v111 offset:18816
P2_SK5:
    s_mov_b64 exec, -1
    s_waitcnt vmcnt(9)
    s_waitcnt lgkmcnt(0)
    s_barrier
    v_lshlrev_b32 v12, 2, v0
    v_cmp_gt_u32 vcc, 512, v0
    v_add_u32 v12, 65024, v12
    s_mov_b64 exec, vcc
    ds_write_b32 v12, v18
    s_mov_b64 exec, -1
    ds_read_b64 v[52:53], v13 offset:0
    ds_read_b64 v[54:55], v13 offset:8192
    ds_read_b64 v[56:57], v13 offset:16384
    ds_read_b64 v[58:59], v13 offset:24576
    ds_read_b64 v[60:61], v13 offset:32768
    ds_read_b64 v[62:63], v13 offset:40960
    ds_read_b64 v[64:65], v13 offset:49152
    ds_read_b64 v[66:67], v13 offset:57344
    s_waitcnt lgkmcnt(0)
    s_max_i32 s14, s89, 0
    s_bfm_b64 exec, s14, 0
    s_cmp_ge_i32 s14, 64
    s_cselect_b64 exec, -1, exec
    v_mov_b32 v84, v53
    buffer_load_dwordx2 v[52:53], v52, s[20:23], 0 offen
    s_mov_b64 exec, -1
    v_mov_b32 v114, 1
    s_mov_b32 s42, 60104
    s_waitcnt vmcnt(9)
    s_max_i32 s14, s86, 0
    s_bfm_b64 exec, s14, 0
    s_cmp_ge_i32 s14, 64
    s_cselect_b64 exec, -1, exec
    v_lshrrev_b32 v12, 11, v20
    v_lshl_add_u32 v12, v12, 2, s42
    ds_add_rtn_u32 v68, v12, v114
    s_mov_b64 exec, -1
    s_waitcnt vmcnt(8)
    s_sub_i32 s14, s86, 64
    s_max_i32 s14, s14, 0
    s_bfm_b64 exec, s14, 0
    s_cmp_ge_i32 s14, 64
    s_cselect_b64 exec, -1, exec
    v_lshrrev_b32 v12, 11, v22
    v_lshl_add_u32 v12, v12, 2, s42
    ds_add_rtn_u32 v69, v12, v114
    s_mov_b64 exec, -1
    s_waitcnt vmcnt(7)
    s_sub_i32 s14, s86, 128
    s_max_i32 s14, s14, 0
    s_bfm_b64 exec, s14, 0
    s_cmp_ge_i32 s14, 64
    s_cselect_b64 exec, -1, exec
    v_lshrrev_b32 v12, 11, v24
    v_lshl_add_u32 v12, v12, 2, s42
    ds_add_rtn_u32 v70, v12, v114
    s_mov_b64 exec, -1
    s_waitcnt vmcnt(6)
    s_sub_i32 s14, s86, 192
    s_max_i32 s14, s14, 0
    s_bfm_b64 exec, s14, 0
    s_cmp_ge_i32 s14, 64
    s_cselect_b64 exec, -1, exec
    v_lshrrev_b32 v12, 11, v26
    v_lshl_add_u32 v12, v12, 2, s42
    ds_add_rtn_u32 v71, v12, v114
    s_mov_b64 exec, -1
    s_waitcnt vmcnt(5)
    s_sub_i32 s14, s86, 256
    s_max_i32 s14, s14, 0
    s_bfm_b64 exec, s14, 0
    s_cmp_ge_i32 s14, 64
    s_cselect_b64 exec, -1, exec
    v_lshrrev_b32 v12, 11, v28
    v_lshl_add_u32 v12, v12, 2, s42
    ds_add_rtn_u32 v72, v12, v114
    s_mov_b64 exec, -1
    s_waitcnt vmcnt(4)
    s_sub_i32 s14, s86, 320
    s_max_i32 s14, s14, 0
    s_bfm_b64 exec, s14, 0
    s_cmp_ge_i32 s14, 64
    s_cselect_b64 exec, -1, exec
    v_lshrrev_b32 v12, 11, v30
    v_lshl_add_u32 v12, v12, 2, s42
    ds_add_rtn_u32 v73, v12, v114
    s_mov_b64 exec, -1
    s_waitcnt vmcnt(3)
    s_sub_i32 s14, s86, 384
    s_max_i32 s14, s14, 0
    s_bfm_b64 exec, s14, 0
    s_cmp_ge_i32 s14, 64
    s_cselect_b64 exec, -1, exec
    v_lshrrev_b32 v12, 11, v32
    v_lshl_add_u32 v12, v12, 2, s42
    ds_add_rtn_u32 v74, v12, v114
    s_mov_b64 exec, -1
    s_waitcnt vmcnt(2)
    s_sub_i32 s14, s86, 448
    s_max_i32 s14, s14, 0
    s_bfm_b64 exec, s14, 0
    s_cmp_ge_i32 s14, 64
    s_cselect_b64 exec, -1, exec
    v_lshrrev_b32 v12, 11, v34
    v_lshl_add_u32 v12, v12, 2, s42
    ds_add_rtn_u32 v75, v12, v114
    s_mov_b64 exec, -1
    s_waitcnt lgkmcnt(0)
    s_waitcnt lgkmcnt(0)
    s_barrier
    s_sub_i32 s14, s84, 320
    s_max_i32 s14, s14, 0
    s_bfm_b64 exec, s14, 0
    s_cmp_ge_i32 s14, 64
    s_cselect_b64 exec, -1, exec
    s_cbranch_execz P2_SK6
    v_and_b32 v94, 0xffff, v81
    v_add_u32 v93, v94, v94
    v_add_u32 v92, v93, v93
    ds_read_b64 v[104:105], v93 offset:25088
    ds_read_b128 v[100:103], v92 offset:37632
    v_and_b32 v95, s3, v81
    v_mul_f32 v96, 0.15915494, v95
    v_mul_f32 v97, 0x40400000, v95
    v_cos_f32 v96, v96
    v_cvt_pk_bf16_f32 v97, 0, v97
    v_mul_f32 v97, 0.15915494, v97
    v_mul_f32 v95, v96, v96
    v_cos_f32 v97, v97
    v_fma_f32 v95, v95, 2.0, -1.0
    v_cvt_pk_bf16_f32 v98, v96, v95
    v_cvt_pk_bf16_f32 v99, v97, 0
    v_cvt_pk_bf16_f32 v106, 0, v97
    s_waitcnt lgkmcnt(1)
    v_dot2_f32_bf16 v112, v104, v99, 0
    v_dot2_f32_bf16 v113, v104, v106, 0
    v_dot2_f32_bf16 v114, v105, v99, 0
    v_dot2_f32_bf16 v115, v105, v106, 0
    s_waitcnt lgkmcnt(0)
    v_dot2_f32_bf16 v112, v100, v98, v112
    v_dot2_f32_bf16 v113, v101, v98, v113
    v_dot2_f32_bf16 v114, v102, v98, v114
    v_dot2_f32_bf16 v115, v103, v98, v115
    s_waitcnt vmcnt(1)
    v_lshlrev_b32 v108, 16, v46
    v_and_b32 v109, s3, v46
    v_lshlrev_b32 v110, 16, v47
    v_and_b32 v111, s3, v47
    s_cmp_lg_u32 s6, 0
    v_mul_f32 v108, v108, v112
    v_mul_f32 v109, v109, v113
    v_mul_f32 v110, v110, v114
    v_mul_f32 v111, v111, v115
    s_cbranch_scc1 P2_FL6
    v_cvt_rpi_i32_f32 v112, v108
    ds_add_u32 v94, v112 offset:0
    v_cvt_rpi_i32_f32 v113, v109
    ds_add_u32 v94, v113 offset:6272
    v_cvt_rpi_i32_f32 v114, v110
    ds_add_u32 v94, v114 offset:12544
    v_cvt_rpi_i32_f32 v115, v111
    ds_add_u32 v94, v115 offset:18816
    s_branch P2_SK6
P2_FL6:
    ds_add_f32 v94, v108 offset:0
    ds_add_f32 v94, v109 offset:6272
    ds_add_f32 v94, v110 offset:12544
    ds_add_f32 v94, v111 offset:18816
P2_SK6:
    s_mov_b64 exec, -1
    s_waitcnt vmcnt(1)
    s_sub_i32 s14, s89, 1024
    s_max_i32 s14, s14, 0
    s_bfm_b64 exec, s14, 0
    s_cmp_ge_i32 s14, 64
    s_cselect_b64 exec, -1, exec
    v_mov_b32 v85, v55
    buffer_load_dwordx2 v[54:55], v54, s[20:23], 0 offen
    s_mov_b64 exec, -1
    s_cmp_lg_u32 s5, 15
    s_cbranch_scc1 P2_NS7
    v_lshlrev_b32 v102, 2, v3
    v_add_u32 v102, 62976, v102
    ds_read_b128 v[92:95], v102
    ds_read_b128 v[96:99], v102 offset:16
    s_waitcnt lgkmcnt(0)
    v_add_u32 v93, v93, v92
    v_add_u32 v94, v94, v93
    v_add_u32 v95, v95, v94
    v_add_u32 v96, v96, v95
    v_add_u32 v97, v97, v96
    v_add_u32 v98, v98, v97
    v_add_u32 v99, v99, v98
    v_mov_b32 v100, v99
    s_nop 1
    v_add_u32_dpp v100, v100, v100 row_shr:1 row_mask:0xf bank_mask:0xf bound_ctrl:0
    s_nop 1
    v_add_u32_dpp v100, v100, v100 row_shr:2 row_mask:0xf bank_mask:0xf bound_ctrl:0
    s_nop 1
    v_add_u32_dpp v100, v100, v100 row_shr:4 row_mask:0xf bank_mask:0xf bound_ctrl:0
    s_nop 1
    v_add_u32_dpp v100, v100, v100 row_shr:8 row_mask:0xf bank_mask:0xf bound_ctrl:0
    s_nop 1
    v_add_u32_dpp v100, v100, v100 row_bcast:15 row_mask:0xa bank_mask:0xf
    s_nop 1
    v_add_u32_dpp v100, v100, v100 row_bcast:31 row_mask:0xc bank_mask:0xf
    s_nop 0
    v_readlane_b32 s14, v100, 63
    v_sub_u32 v100, v100, v99
    v_add_u32 v99, v98, v100
    v_add_u32 v98, v97, v100
    v_add_u32 v97, v96, v100
    v_add_u32 v96, v95, v100
    v_add_u32 v95, v94, v100
    v_add_u32 v94, v93, v100
    v_add_u32 v93, v92, v100
    v_mov_b32 v92, v100
    ds_write_b128 v102, v[92:95]
    ds_write_b128 v102, v[96:99] offset:16
    v_mov_b32 v101, s14
    v_mov_b32 v103, 62848
    ds_write_b32 v103, v101
    s_waitcnt lgkmcnt(0)
P2_NS7:
    s_max_i32 s14, s89, 0
    s_bfm_b64 exec, s14, 0
    s_cmp_ge_i32 s14, 64
    s_cselect_b64 exec, -1, exec
    s_cbranch_execz P2_SK8
    v_and_b32 v94, 0xffff, v84
    v_add_u32 v93, v94, v94
    v_add_u32 v92, v93, v93
    ds_read_b64 v[104:105], v93 offset:25088
    ds_read_b128 v[100:103], v92 offset:37632
    v_and_b32 v95, s3, v84
    v_mul_f32 v96, 0.15915494, v95
    v_mul_f32 v97, 0x40400000, v95
    v_cos_f32 v96, v96
    v_cvt_pk_bf16_f32 v97, 0, v97
    v_mul_f32 v97, 0.15915494, v97
    v_mul_f32 v95, v96, v96
    v_cos_f32 v97, v97
    v_fma_f32 v95, v95, 2.0, -1.0
    v_cvt_pk_bf16_f32 v98, v96, v95
    v_cvt_pk_bf16_f32 v99, v97, 0
    v_cvt_pk_bf16_f32 v106, 0, v97
    s_waitcnt lgkmcnt(1)
    v_dot2_f32_bf16 v112, v104, v99, 0
    v_dot2_f32_bf16 v113, v104, v106, 0
    v_dot2_f32_bf16 v114, v105, v99, 0
    v_dot2_f32_bf16 v115, v105, v106, 0
    s_waitcnt lgkmcnt(0)
    v_dot2_f32_bf16 v112, v100, v98, v112
    v_dot2_f32_bf16 v113, v101, v98, v113
    v_dot2_f32_bf16 v114, v102, v98, v114
    v_dot2_f32_bf16 v115, v103, v98, v115
    s_waitcnt vmcnt(1)
    v_lshlrev_b32 v108, 16, v52
    v_and_b32 v109, s3, v52
    v_lshlrev_b32 v110, 16, v53
    v_and_b32 v111, s3, v53
    s_cmp_lg_u32 s6, 0
    v_mul_f32 v108, v108, v112
    v_mul_f32 v109, v109, v113
    v_mul_f32 v110, v110, v114
    v_mul_f32 v111, v111, v115
    s_cbranch_scc1 P2_FL8
    v_cvt_rpi_i32_f32 v112, v108
    ds_add_u32 v94, v112 offset:0
    v_cvt_rpi_i32_f32 v113, v109
    ds_add_u32 v94, v113 offset:6272
    v_cvt_rpi_i32_f32 v114, v110
    ds_add_u32 v94, v114 offset:12544
    v_cvt_rpi_i32_f32 v115, v111
    ds_add_u32 v94, v115 offset:18816
    s_branch P2_SK8
P2_FL8:
    ds_add_f32 v94, v108 offset:0
    ds_add_f32 v94, v109 offset:6272
    ds_add_f32 v94, v110 offset:12544
    ds_add_f32 v94, v111 offset:18816
P2_SK8:
    s_mov_b64 exec, -1
    s_waitcnt vmcnt(1)
    s_sub_i32 s14, s89, 2048
    s_max_i32 s14, s14, 0
    s_bfm_b64 exec, s14, 0
    s_cmp_ge_i32 s14, 64
    s_cselect_b64 exec, -1, exec
    v_mov_b32 v86, v57
    buffer_load_dwordx2 v[56:57], v56, s[20:23], 0 offen
    s_mov_b64 exec, -1
    s_waitcnt lgkmcnt(0)
    s_barrier
    s_mov_b32 s42, 60104
    s_mov_b32 s43, 83456
    v_mov_b32 v100, 62848
    ds_read_b32 v100, v100
    v_lshrrev_b32 v102, 11, v20
    v_lshl_add_u32 v102, v102, 2, s42
    s_max_i32 s14, s86, 0
    s_bfm_b64 exec, s14, 0
    s_cmp_ge_i32 s14, 64
    s_cselect_b64 exec, -1, exec
    ds_read_b32 v102, v102
    s_mov_b64 exec, -1
    v_lshrrev_b32 v103, 11, v22
    v_lshl_add_u32 v103, v103, 2, s42
    s_sub_i32 s14, s86, 64
    s_max_i32 s14, s14, 0
    s_bfm_b64 exec, s14, 0
    s_cmp_ge_i32 s14, 64
    s_cselect_b64 exec, -1, exec
    ds_read_b32 v103, v103
    s_mov_b64 exec, -1
    v_lshrrev_b32 v104, 11, v24
    v_lshl_add_u32 v104, v104, 2, s42
    s_sub_i32 s14, s86, 128
    s_max_i32 s14, s14, 0
    s_bfm_b64 exec, s14, 0
    s_cmp_ge_i32 s14, 64
    s_cselect_b64 exec, -1, exec
    ds_read_b32 v104, v104
    s_mov_b64 exec, -1
    v_lshrrev_b32 v105, 11, v26
    v_lshl_add_u32 v105, v105, 2, s42
    s_sub_i32 s14, s86, 192
    s_max_i32 s14, s14, 0
    s_bfm_b64 exec, s14, 0
    s_cmp_ge_i32 s14, 64
    s_cselect_b64 exec, -1, exec
    ds_read_b32 v105, v105
    s_mov_b64 exec, -1
    v_lshrrev_b32 v106, 11, v28
    v_lshl_add_u32 v106, v106, 2, s42
    s_sub_i32 s14, s86, 256
    s_max_i32 s14, s14, 0
    s_bfm_b64 exec, s14, 0
    s_cmp_ge_i32 s14, 64
    s_cselect_b64 exec, -1, exec
    ds_read_b32 v106, v106
    s_mov_b64 exec, -1
    v_lshrrev_b32 v107, 11, v30
    v_lshl_add_u32 v107, v107, 2, s42
    s_sub_i32 s14, s86, 320
    s_max_i32 s14, s14, 0
    s_bfm_b64 exec, s14, 0
    s_cmp_ge_i32 s14, 64
    s_cselect_b64 exec, -1, exec
    ds_read_b32 v107, v107
    s_mov_b64 exec, -1
    v_lshrrev_b32 v108, 11, v32
    v_lshl_add_u32 v108, v108, 2, s42
    s_sub_i32 s14, s86, 384
    s_max_i32 s14, s14, 0
    s_bfm_b64 exec, s14, 0
    s_cmp_ge_i32 s14, 64
    s_cselect_b64 exec, -1, exec
    ds_read_b32 v108, v108
    s_mov_b64 exec, -1
    v_lshrrev_b32 v109, 11, v34
    v_lshl_add_u32 v109, v109, 2, s42
    s_sub_i32 s14, s86, 448
    s_max_i32 s14, s14, 0
    s_bfm_b64 exec, s14, 0
    s_cmp_ge_i32 s14, 64
    s_cselect_b64 exec, -1, exec
    ds_read_b32 v109, v109
    s_mov_b64 exec, -1
    s_waitcnt lgkmcnt(8)
    v_readfirstlane_b32 s88, v100
    s_lshl_b32 s15, s5, 6
    s_sub_i32 s88, s88, s15
    s_waitcnt lgkmcnt(7)
    v_add_u32 v102, v102, v68
    v_lshl_add_u32 v102, v102, 3, s43
    s_max_i32 s14, s86, 0
    s_bfm_b64 exec, s14, 0
    s_cmp_ge_i32 s14, 64
    s_cselect_b64 exec, -1, exec
    ds_write_b64 v102, v[20:21]
    s_mov_b64 exec, -1
    s_waitcnt lgkmcnt(7)
    v_add_u32 v103, v103, v69
    v_lshl_add_u32 v103, v103, 3, s43
    s_sub_i32 s14, s86, 64
    s_max_i32 s14, s14, 0
    s_bfm_b64 exec, s14, 0
    s_cmp_ge_i32 s14, 64
    s_cselect_b64 exec, -1, exec
    ds_write_b64 v103, v[22:23]
    s_mov_b64 exec, -1
    s_waitcnt lgkmcnt(7)
    v_add_u32 v104, v104, v70
    v_lshl_add_u32 v104, v104, 3, s43
    s_sub_i32 s14, s86, 128
    s_max_i32 s14, s14, 0
    s_bfm_b64 exec, s14, 0
    s_cmp_ge_i32 s14, 64
    s_cselect_b64 exec, -1, exec
    ds_write_b64 v104, v[24:25]
    s_mov_b64 exec, -1
    s_waitcnt lgkmcnt(7)
    v_add_u32 v105, v105, v71
    v_lshl_add_u32 v105, v105, 3, s43
    s_sub_i32 s14, s86, 192
    s_max_i32 s14, s14, 0
    s_bfm_b64 exec, s14, 0
    s_cmp_ge_i32 s14, 64
    s_cselect_b64 exec, -1, exec
    ds_write_b64 v105, v[26:27]
    s_mov_b64 exec, -1
    s_waitcnt lgkmcnt(7)
    v_add_u32 v106, v106, v72
    v_lshl_add_u32 v106, v106, 3, s43
    s_sub_i32 s14, s86, 256
    s_max_i32 s14, s14, 0
    s_bfm_b64 exec, s14, 0
    s_cmp_ge_i32 s14, 64
    s_cselect_b64 exec, -1, exec
    ds_write_b64 v106, v[28:29]
    s_mov_b64 exec, -1
    s_waitcnt lgkmcnt(7)
    v_add_u32 v107, v107, v73
    v_lshl_add_u32 v107, v107, 3, s43
    s_sub_i32 s14, s86, 320
    s_max_i32 s14, s14, 0
    s_bfm_b64 exec, s14, 0
    s_cmp_ge_i32 s14, 64
    s_cselect_b64 exec, -1, exec
    ds_write_b64 v107, v[30:31]
    s_mov_b64 exec, -1
    s_waitcnt lgkmcnt(7)
    v_add_u32 v108, v108, v74
    v_lshl_add_u32 v108, v108, 3, s43
    s_sub_i32 s14, s86, 384
    s_max_i32 s14, s14, 0
    s_bfm_b64 exec, s14, 0
    s_cmp_ge_i32 s14, 64
    s_cselect_b64 exec, -1, exec
    ds_write_b64 v108, v[32:33]
    s_mov_b64 exec, -1
    s_waitcnt lgkmcnt(7)
    v_add_u32 v109, v109, v75
    v_lshl_add_u32 v109, v109, 3, s43
    s_sub_i32 s14, s86, 448
    s_max_i32 s14, s14, 0
    s_bfm_b64 exec, s14, 0
    s_cmp_ge_i32 s14, 64
    s_cselect_b64 exec, -1, exec
    ds_write_b64 v109, v[34:35]
    s_mov_b64 exec, -1
    s_sub_i32 s14, s89, 1024
    s_max_i32 s14, s14, 0
    s_bfm_b64 exec, s14, 0
    s_cmp_ge_i32 s14, 64
    s_cselect_b64 exec, -1, exec
    s_cbranch_execz P2_SK9
    v_and_b32 v94, 0xffff, v85
    v_add_u32 v93, v94, v94
    v_add_u32 v92, v93, v93
    ds_read_b64 v[104:105], v93 offset:25088
    ds_read_b128 v[100:103], v92 offset:37632
    v_and_b32 v95, s3, v85
    v_mul_f32 v96, 0.15915494, v95
    v_mul_f32 v97, 0x40400000, v95
    v_cos_f32 v96, v96
    v_cvt_pk_bf16_f32 v97, 0, v97
    v_mul_f32 v97, 0.15915494, v97
    v_mul_f32 v95, v96, v96
    v_cos_f32 v97, v97
    v_fma_f32 v95, v95, 2.0, -1.0
    v_cvt_pk_bf16_f32 v98, v96, v95
    v_cvt_pk_bf16_f32 v99, v97, 0
    v_cvt_pk_bf16_f32 v106, 0, v97
    s_waitcnt lgkmcnt(1)
    v_dot2_f32_bf16 v112, v104, v99, 0
    v_dot2_f32_bf16 v113, v104, v106, 0
    v_dot2_f32_bf16 v114, v105, v99, 0
    v_dot2_f32_bf16 v115, v105, v106, 0
    s_waitcnt lgkmcnt(0)
    v_dot2_f32_bf16 v112, v100, v98, v112
    v_dot2_f32_bf16 v113, v101, v98, v113
    v_dot2_f32_bf16 v114, v102, v98, v114
    v_dot2_f32_bf16 v115, v103, v98, v115
    s_waitcnt vmcnt(1)
    v_lshlrev_b32 v108, 16, v54
    v_and_b32 v109, s3, v54
    v_lshlrev_b32 v110, 16, v55
    v_and_b32 v111, s3, v55
    s_cmp_lg_u32 s6, 0
    v_mul_f32 v108, v108, v112
    v_mul_f32 v109, v109, v113
    v_mul_f32 v110, v110, v114
    v_mul_f32 v111, v111, v115
    s_cbranch_scc1 P2_FL9
    v_cvt_rpi_i32_f32 v112, v108
    ds_add_u32 v94, v112 offset:0
    v_cvt_rpi_i32_f32 v113, v109
    ds_add_u32 v94, v113 offset:6272
    v_cvt_rpi_i32_f32 v114, v110
    ds_add_u32 v94, v114 offset:12544
    v_cvt_rpi_i32_f32 v115, v111
    ds_add_u32 v94, v115 offset:18816
    s_branch P2_SK9
P2_FL9:
    ds_add_f32 v94, v108 offset:0
    ds_add_f32 v94, v109 offset:6272
    ds_add_f32 v94, v110 offset:12544
    ds_add_f32 v94, v111 offset:18816
P2_SK9:
    s_mov_b64 exec, -1
    s_waitcnt vmcnt(1)
    s_sub_i32 s14, s89, 3072
    s_max_i32 s14, s14, 0
    s_bfm_b64 exec, s14, 0
    s_cmp_ge_i32 s14, 64
    s_cselect_b64 exec, -1, exec
    v_mov_b32 v87, v59
    buffer_load_dwordx2 v[58:59], v58, s[20:23], 0 offen
    s_mov_b64 exec, -1
    s_waitcnt lgkmcnt(0)
    ds_write_b64 v2, v[18:19] offset:0
    ds_write_b64 v2, v[18:19] offset:512
    s_add_u32 s15, s79, 0
    v_subrev_u32 v12, s15, v7
    v_cmp_gt_u32 vcc, 256, v12
    v_lshl_add_u32 v12, v12, 2, s7
    s_mov_b64 exec, vcc
    ds_write_b32 v12, v11
    s_mov_b64 exec, -1
    ds_read_b32 v20, v1 offset:0
    ds_read_b32 v22, v1 offset:256
    ds_read_b32 v24, v1 offset:512
    ds_read_b32 v26, v1 offset:768
    s_lshl_b32 s15, s15, 3
    s_waitcnt lgkmcnt(0)
    v_max_u32_dpp v20, v20, v20 row_shr:1 row_mask:0xf bank_mask:0xf bound_ctrl:0
    v_max_u32_dpp v22, v22, v22 row_shr:1 row_mask:0xf bank_mask:0xf bound_ctrl:0
    v_max_u32_dpp v24, v24, v24 row_shr:1 row_mask:0xf bank_mask:0xf bound_ctrl:0
    v_max_u32_dpp v26, v26, v26 row_shr:1 row_mask:0xf bank_mask:0xf bound_ctrl:0
    v_max_u32_dpp v20, v20, v20 row_shr:2 row_mask:0xf bank_mask:0xf bound_ctrl:0
    v_max_u32_dpp v22, v22, v22 row_shr:2 row_mask:0xf bank_mask:0xf bound_ctrl:0
    v_max_u32_dpp v24, v24, v24 row_shr:2 row_mask:0xf bank_mask:0xf bound_ctrl:0
    v_max_u32_dpp v26, v26, v26 row_shr:2 row_mask:0xf bank_mask:0xf bound_ctrl:0
    v_max_u32_dpp v20, v20, v20 row_shr:4 row_mask:0xf bank_mask:0xf bound_ctrl:0
    v_max_u32_dpp v22, v22, v22 row_shr:4 row_mask:0xf bank_mask:0xf bound_ctrl:0
    v_max_u32_dpp v24, v24, v24 row_shr:4 row_mask:0xf bank_mask:0xf bound_ctrl:0
    v_max_u32_dpp v26, v26, v26 row_shr:4 row_mask:0xf bank_mask:0xf bound_ctrl:0
    v_max_u32_dpp v20, v20, v20 row_shr:8 row_mask:0xf bank_mask:0xf bound_ctrl:0
    v_max_u32_dpp v22, v22, v22 row_shr:8 row_mask:0xf bank_mask:0xf bound_ctrl:0
    v_max_u32_dpp v24, v24, v24 row_shr:8 row_mask:0xf bank_mask:0xf bound_ctrl:0
    v_max_u32_dpp v26, v26, v26 row_shr:8 row_mask:0xf bank_mask:0xf bound_ctrl:0
    v_max_u32_dpp v20, v20, v20 row_bcast:15 row_mask:0xa bank_mask:0xf
    v_max_u32_dpp v22, v22, v22 row_bcast:15 row_mask:0xa bank_mask:0xf
    v_max_u32_dpp v24, v24, v24 row_bcast:15 row_mask:0xa bank_mask:0xf
    v_max_u32_dpp v26, v26, v26 row_bcast:15 row_mask:0xa bank_mask:0xf
    v_max_u32_dpp v20, v20, v20 row_bcast:31 row_mask:0xc bank_mask:0xf
    v_max_u32_dpp v22, v22, v22 row_bcast:31 row_mask:0xc bank_mask:0xf
    v_max_u32_dpp v24, v24, v24 row_bcast:31 row_mask:0xc bank_mask:0xf
    v_max_u32_dpp v26, v26, v26 row_bcast:31 row_mask:0xc bank_mask:0xf
    v_max_u32 v20, s83, v20
    s_nop 0
    v_readlane_b32 s83, v20, 63
    v_add3_u32 v20, v20, v3, s15
    s_add_u32 s15, s15, 512
    s_max_i32 s14, s87, 0
    s_bfm_b64 exec, s14, 0
    s_cmp_ge_i32 s14, 64
    s_cselect_b64 exec, -1, exec
    buffer_load_dwordx2 v[20:21], v20, s[16:19], 0 offen
    s_mov_b64 exec, -1
    v_max_u32 v22, s83, v22
    s_nop 0
    v_readlane_b32 s83, v22, 63
    v_add3_u32 v22, v22, v3, s15
    s_add_u32 s15, s15, 512
    s_sub_i32 s14, s87, 64
    s_max_i32 s14, s14, 0
    s_bfm_b64 exec, s14, 0
    s_cmp_ge_i32 s14, 64
    s_cselect_b64 exec, -1, exec
    buffer_load_dwordx2 v[22:23], v22, s[16:19], 0 offen
    s_mov_b64 exec, -1
    v_max_u32 v24, s83, v24
    s_nop 0
    v_readlane_b32 s83, v24, 63
    v_add3_u32 v24, v24, v3, s15
    s_add_u32 s15, s15, 512
    s_sub_i32 s14, s87, 128
    s_max_i32 s14, s14, 0
    s_bfm_b64 exec, s14, 0
    s_cmp_ge_i32 s14, 64
    s_cselect_b64 exec, -1, exec
    buffer_load_dwordx2 v[24:25], v24, s[16:19], 0 offen
    s_mov_b64 exec, -1
    v_max_u32 v26, s83, v26
    s_nop 0
    v_readlane_b32 s83, v26, 63
    v_add3_u32 v26, v26, v3, s15
    s_add_u32 s15, s15, 512
    s_sub_i32 s14, s87, 192
    s_max_i32 s14, s14, 0
    s_bfm_b64 exec, s14, 0
    s_cmp_ge_i32 s14, 64
    s_cselect_b64 exec, -1, exec
    buffer_load_dwordx2 v[26:27], v26, s[16:19], 0 offen
    s_mov_b64 exec, -1
    s_sub_i32 s14, s89, 2048
    s_max_i32 s14, s14, 0
    s_bfm_b64 exec, s14, 0
    s_cmp_ge_i32 s14, 64
    s_cselect_b64 exec, -1, exec
    s_cbranch_execz P2_SK10
    v_and_b32 v94, 0xffff, v86
    v_add_u32 v93, v94, v94
    v_add_u32 v92, v93, v93
    ds_read_b64 v[104:105], v93 offset:25088
    ds_read_b128 v[100:103], v92 offset:37632
    v_and_b32 v95, s3, v86
    v_mul_f32 v96, 0.15915494, v95
    v_mul_f32 v97, 0x40400000, v95
    v_cos_f32 v96, v96
    v_cvt_pk_bf16_f32 v97, 0, v97
    v_mul_f32 v97, 0.15915494, v97
    v_mul_f32 v95, v96, v96
    v_cos_f32 v97, v97
    v_fma_f32 v95, v95, 2.0, -1.0
    v_cvt_pk_bf16_f32 v98, v96, v95
    v_cvt_pk_bf16_f32 v99, v97, 0
    v_cvt_pk_bf16_f32 v106, 0, v97
    s_waitcnt lgkmcnt(1)
    v_dot2_f32_bf16 v112, v104, v99, 0
    v_dot2_f32_bf16 v113, v104, v106, 0
    v_dot2_f32_bf16 v114, v105, v99, 0
    v_dot2_f32_bf16 v115, v105, v106, 0
    s_waitcnt lgkmcnt(0)
    v_dot2_f32_bf16 v112, v100, v98, v112
    v_dot2_f32_bf16 v113, v101, v98, v113
    v_dot2_f32_bf16 v114, v102, v98, v114
    v_dot2_f32_bf16 v115, v103, v98, v115
    s_waitcnt vmcnt(5)
    v_lshlrev_b32 v108, 16, v56
    v_and_b32 v109, s3, v56
    v_lshlrev_b32 v110, 16, v57
    v_and_b32 v111, s3, v57
    s_cmp_lg_u32 s6, 0
    v_mul_f32 v108, v108, v112
    v_mul_f32 v109, v109, v113
    v_mul_f32 v110, v110, v114
    v_mul_f32 v111, v111, v115
    s_cbranch_scc1 P2_FL10
    v_cvt_rpi_i32_f32 v112, v108
    ds_add_u32 v94, v112 offset:0
    v_cvt_rpi_i32_f32 v113, v109
    ds_add_u32 v94, v113 offset:6272
    v_cvt_rpi_i32_f32 v114, v110
    ds_add_u32 v94, v114 offset:12544
    v_cvt_rpi_i32_f32 v115, v111
    ds_add_u32 v94, v115 offset:18816
    s_branch P2_SK10
P2_FL10:
    ds_add_f32 v94, v108 offset:0
    ds_add_f32 v94, v109 offset:6272
    ds_add_f32 v94, v110 offset:12544
    ds_add_f32 v94, v111 offset:18816
P2_SK10:
    s_mov_b64 exec, -1
    s_waitcnt vmcnt(5)
    s_sub_i32 s14, s89, 4096
    s_max_i32 s14, s14, 0
    s_bfm_b64 exec, s14, 0
    s_cmp_ge_i32 s14, 64
    s_cselect_b64 exec, -1, exec
    v_mov_b32 v88, v61
    buffer_load_dwordx2 v[60:61], v60, s[20:23], 0 offen
    s_mov_b64 exec, -1
    ds_write_b64 v2, v[18:19] offset:0
    ds_write_b64 v2, v[18:19] offset:512
    s_add_u32 s15, s79, 256
    v_subrev_u32 v12, s15, v7
    v_cmp_gt_u32 vcc, 256, v12
    v_lshl_add_u32 v12, v12, 2, s7
    s_mov_b64 exec, vcc
    ds_write_b32 v12, v11
    s_mov_b64 exec, -1
    ds_read_b32 v28, v1 offset:0
    ds_read_b32 v30, v1 offset:256
    ds_read_b32 v32, v1 offset:512
    ds_read_b32 v34, v1 offset:768
    s_lshl_b32 s15, s15, 3
    s_waitcnt lgkmcnt(0)
    v_max_u32_dpp v28, v28, v28 row_shr:1 row_mask:0xf bank_mask:0xf bound_ctrl:0
    v_max_u32_dpp v30, v30, v30 row_shr:1 row_mask:0xf bank_mask:0xf bound_ctrl:0
    v_max_u32_dpp v32, v32, v32 row_shr:1 row_mask:0xf bank_mask:0xf bound_ctrl:0
    v_max_u32_dpp v34, v34, v34 row_shr:1 row_mask:0xf bank_mask:0xf bound_ctrl:0
    v_max_u32_dpp v28, v28, v28 row_shr:2 row_mask:0xf bank_mask:0xf bound_ctrl:0
    v_max_u32_dpp v30, v30, v30 row_shr:2 row_mask:0xf bank_mask:0xf bound_ctrl:0
    v_max_u32_dpp v32, v32, v32 row_shr:2 row_mask:0xf bank_mask:0xf bound_ctrl:0
    v_max_u32_dpp v34, v34, v34 row_shr:2 row_mask:0xf bank_mask:0xf bound_ctrl:0
    v_max_u32_dpp v28, v28, v28 row_shr:4 row_mask:0xf bank_mask:0xf bound_ctrl:0
    v_max_u32_dpp v30, v30, v30 row_shr:4 row_mask:0xf bank_mask:0xf bound_ctrl:0
    v_max_u32_dpp v32, v32, v32 row_shr:4 row_mask:0xf bank_mask:0xf bound_ctrl:0
    v_max_u32_dpp v34, v34, v34 row_shr:4 row_mask:0xf bank_mask:0xf bound_ctrl:0
    v_max_u32_dpp v28, v28, v28 row_shr:8 row_mask:0xf bank_mask:0xf bound_ctrl:0
    v_max_u32_dpp v30, v30, v30 row_shr:8 row_mask:0xf bank_mask:0xf bound_ctrl:0
    v_max_u32_dpp v32, v32, v32 row_shr:8 row_mask:0xf bank_mask:0xf bound_ctrl:0
    v_max_u32_dpp v34, v34, v34 row_shr:8 row_mask:0xf bank_mask:0xf bound_ctrl:0
    v_max_u32_dpp v28, v28, v28 row_bcast:15 row_mask:0xa bank_mask:0xf
    v_max_u32_dpp v30, v30, v30 row_bcast:15 row_mask:0xa bank_mask:0xf
    v_max_u32_dpp v32, v32, v32 row_bcast:15 row_mask:0xa bank_mask:0xf
    v_max_u32_dpp v34, v34, v34 row_bcast:15 row_mask:0xa bank_mask:0xf
    v_max_u32_dpp v28, v28, v28 row_bcast:31 row_mask:0xc bank_mask:0xf
    v_max_u32_dpp v30, v30, v30 row_bcast:31 row_mask:0xc bank_mask:0xf
    v_max_u32_dpp v32, v32, v32 row_bcast:31 row_mask:0xc bank_mask:0xf
    v_max_u32_dpp v34, v34, v34 row_bcast:31 row_mask:0xc bank_mask:0xf
    v_max_u32 v28, s83, v28
    s_nop 0
    v_readlane_b32 s83, v28, 63
    v_add3_u32 v28, v28, v3, s15
    s_add_u32 s15, s15, 512
    s_sub_i32 s14, s87, 256
    s_max_i32 s14, s14, 0
    s_bfm_b64 exec, s14, 0
    s_cmp_ge_i32 s14, 64
    s_cselect_b64 exec, -1, exec
    buffer_load_dwordx2 v[28:29], v28, s[16:19], 0 offen
    s_mov_b64 exec, -1
    v_max_u32 v30, s83, v30
    s_nop 0
    v_readlane_b32 s83, v30, 63
    v_add3_u32 v30, v30, v3, s15
    s_add_u32 s15, s15, 512
    s_sub_i32 s14, s87, 320
    s_max_i32 s14, s14, 0
    s_bfm_b64 exec, s14, 0
    s_cmp_ge_i32 s14, 64
    s_cselect_b64 exec, -1, exec
    buffer_load_dwordx2 v[30:31], v30, s[16:19], 0 offen
    s_mov_b64 exec, -1
    v_max_u32 v32, s83, v32
    s_nop 0
    v_readlane_b32 s83, v32, 63
    v_add3_u32 v32, v32, v3, s15
    s_add_u32 s15, s15, 512
    s_sub_i32 s14, s87, 384
    s_max_i32 s14, s14, 0
    s_bfm_b64 exec, s14, 0
    s_cmp_ge_i32 s14, 64
    s_cselect_b64 exec, -1, exec
    buffer_load_dwordx2 v[32:33], v32, s[16:19], 0 offen
    s_mov_b64 exec, -1
    v_max_u32 v34, s83, v34
    s_nop 0
    v_readlane_b32 s83, v34, 63
    v_add3_u32 v34, v34, v3, s15
    s_add_u32 s15, s15, 512
    s_sub_i32 s14, s87, 448
    s_max_i32 s14, s14, 0
    s_bfm_b64 exec, s14, 0
    s_cmp_ge_i32 s14, 64
    s_cselect_b64 exec, -1, exec
    buffer_load_dwordx2 v[34:35], v34, s[16:19], 0 offen
    s_mov_b64 exec, -1
    s_sub_i32 s14, s89, 3072
    s_max_i32 s14, s14, 0
    s_bfm_b64 exec, s14, 0
    s_cmp_ge_i32 s14, 64
    s_cselect_b64 exec, -1, exec
    s_cbranch_execz P2_SK11
    v_and_b32 v94, 0xffff, v87
    v_add_u32 v93, v94, v94
    v_add_u32 v92, v93, v93
    ds_read_b64 v[104:105], v93 offset:25088
    ds_read_b128 v[100:103], v92 offset:37632
    v_and_b32 v95, s3, v87
    v_mul_f32 v96, 0.15915494, v95
    v_mul_f32 v97, 0x40400000, v95
    v_cos_f32 v96, v96
    v_cvt_pk_bf16_f32 v97, 0, v97
    v_mul_f32 v97, 0.15915494, v97
    v_mul_f32 v95, v96, v96
    v_cos_f32 v97, v97
    v_fma_f32 v95, v95, 2.0, -1.0
    v_cvt_pk_bf16_f32 v98, v96, v95
    v_cvt_pk_bf16_f32 v99, v97, 0
    v_cvt_pk_bf16_f32 v106, 0, v97
    s_waitcnt lgkmcnt(1)
    v_dot2_f32_bf16 v112, v104, v99, 0
    v_dot2_f32_bf16 v113, v104, v106, 0
    v_dot2_f32_bf16 v114, v105, v99, 0
    v_dot2_f32_bf16 v115, v105, v106, 0
    s_waitcnt lgkmcnt(0)
    v_dot2_f32_bf16 v112, v100, v98, v112
    v_dot2_f32_bf16 v113, v101, v98, v113
    v_dot2_f32_bf16 v114, v102, v98, v114
    v_dot2_f32_bf16 v115, v103, v98, v115
    s_waitcnt vmcnt(9)
    v_lshlrev_b32 v108, 16, v58
    v_and_b32 v109, s3, v58
    v_lshlrev_b32 v110, 16, v59
    v_and_b32 v111, s3, v59
    s_cmp_lg_u32 s6, 0
    v_mul_f32 v108, v108, v112
    v_mul_f32 v109, v109, v113
    v_mul_f32 v110, v110, v114
    v_mul_f32 v111, v111, v115
    s_cbranch_scc1 P2_FL11
    v_cvt_rpi_i32_f32 v112, v108
    ds_add_u32 v94, v112 offset:0
    v_cvt_rpi_i32_f32 v113, v109
    ds_add_u32 v94, v113 offset:6272
    v_cvt_rpi_i32_f32 v114, v110
    ds_add_u32 v94, v114 offset:12544
    v_cvt_rpi_i32_f32 v115, v111
    ds_add_u32 v94, v115 offset:18816
    s_branch P2_SK11
P2_FL11:
    ds_add_f32 v94, v108 offset:0
    ds_add_f32 v94, v109 offset:6272
    ds_add_f32 v94, v110 offset:12544
    ds_add_f32 v94, v111 offset:18816
P2_SK11:
    s_mov_b64 exec, -1
    s_waitcnt vmcnt(9)
    s_sub_i32 s14, s89, 5120
    s_max_i32 s14, s14, 0
    s_bfm_b64 exec, s14, 0
    s_cmp_ge_i32 s14, 64
    s_cselect_b64 exec, -1, exec
    v_mov_b32 v89, v63
    buffer_load_dwordx2 v[62:63], v62, s[20:23], 0 offen
    s_mov_b64 exec, -1
    s_sub_i32 s14, s89, 4096
    s_max_i32 s14, s14, 0
    s_bfm_b64 exec, s14, 0
    s_cmp_ge_i32 s14, 64
    s_cselect_b64 exec, -1, exec
    s_cbranch_execz P2_SK12
    v_and_b32 v94, 0xffff, v88
    v_add_u32 v93, v94, v94
    v_add_u32 v92, v93, v93
    ds_read_b64 v[104:105], v93 offset:25088
    ds_read_b128 v[100:103], v92 offset:37632
    v_and_b32 v95, s3, v88
    v_mul_f32 v96, 0.15915494, v95
    v_mul_f32 v97, 0x40400000, v95
    v_cos_f32 v96, v96
    v_cvt_pk_bf16_f32 v97, 0, v97
    v_mul_f32 v97, 0.15915494, v97
    v_mul_f32 v95, v96, v96
    v_cos_f32 v97, v97
    v_fma_f32 v95, v95, 2.0, -1.0
    v_cvt_pk_bf16_f32 v98, v96, v95
    v_cvt_pk_bf16_f32 v99, v97, 0
    v_cvt_pk_bf16_f32 v106, 0, v97
    s_waitcnt lgkmcnt(1)
    v_dot2_f32_bf16 v112, v104, v99, 0
    v_dot2_f32_bf16 v113, v104, v106, 0
    v_dot2_f32_bf16 v114, v105, v99, 0
    v_dot2_f32_bf16 v115, v105, v106, 0
    s_waitcnt lgkmcnt(0)
    v_dot2_f32_bf16 v112, v100, v98, v112
    v_dot2_f32_bf16 v113, v101, v98, v113
    v_dot2_f32_bf16 v114, v102, v98, v114
    v_dot2_f32_bf16 v115, v103, v98, v115
    s_waitcnt vmcnt(5)
    v_lshlrev_b32 v108, 16, v60
    v_and_b32 v109, s3, v60
    v_lshlrev_b32 v110, 16, v61
    v_and_b32 v111, s3, v61
    s_cmp_lg_u32 s6, 0
    v_mul_f32 v108, v108, v112
    v_mul_f32 v109, v109, v113
    v_mul_f32 v110, v110, v114
    v_mul_f32 v111, v111, v115
    s_cbranch_scc1 P2_FL12
    v_cvt_rpi_i32_f32 v112, v108
    ds_add_u32 v94, v112 offset:0
    v_cvt_rpi_i32_f32 v113, v109
    ds_add_u32 v94, v113 offset:6272
    v_cvt_rpi_i32_f32 v114, v110
    ds_add_u32 v94, v114 offset:12544
    v_cvt_rpi_i32_f32 v115, v111
    ds_add_u32 v94, v115 offset:18816
    s_branch P2_SK12
P2_FL12:
    ds_add_f32 v94, v108 offset:0
    ds_add_f32 v94, v109 offset:6272
    ds_add_f32 v94, v110 offset:12544
    ds_add_f32 v94, v111 offset:18816
P2_SK12:
    s_mov_b64 exec, -1
    s_waitcnt vmcnt(5)
    s_sub_i32 s14, s89, 6144
    s_max_i32 s14, s14, 0
    s_bfm_b64 exec, s14, 0
    s_cmp_ge_i32 s14, 64
    s_cselect_b64 exec, -1, exec
    v_mov_b32 v90, v65
    buffer_load_dwordx2 v[64:65], v64, s[20:23], 0 offen
    s_mov_b64 exec, -1
    s_sub_i32 s14, s89, 5120
    s_max_i32 s14, s14, 0
    s_bfm_b64 exec, s14, 0
    s_cmp_ge_i32 s14, 64
    s_cselect_b64 exec, -1, exec
    s_cbranch_execz P2_SK13
    v_and_b32 v94, 0xffff, v89
    v_add_u32 v93, v94, v94
    v_add_u32 v92, v93, v93
    ds_read_b64 v[104:105], v93 offset:25088
    ds_read_b128 v[100:103], v92 offset:37632
    v_and_b32 v95, s3, v89
    v_mul_f32 v96, 0.15915494, v95
    v_mul_f32 v97, 0x40400000, v95
    v_cos_f32 v96, v96
    v_cvt_pk_bf16_f32 v97, 0, v97
    v_mul_f32 v97, 0.15915494, v97
    v_mul_f32 v95, v96, v96
    v_cos_f32 v97, v97
    v_fma_f32 v95, v95, 2.0, -1.0
    v_cvt_pk_bf16_f32 v98, v96, v95
    v_cvt_pk_bf16_f32 v99, v97, 0
    v_cvt_pk_bf16_f32 v106, 0, v97
    s_waitcnt lgkmcnt(1)
    v_dot2_f32_bf16 v112, v104, v99, 0
    v_dot2_f32_bf16 v113, v104, v106, 0
    v_dot2_f32_bf16 v114, v105, v99, 0
    v_dot2_f32_bf16 v115, v105, v106, 0
    s_waitcnt lgkmcnt(0)
    v_dot2_f32_bf16 v112, v100, v98, v112
    v_dot2_f32_bf16 v113, v101, v98, v113
    v_dot2_f32_bf16 v114, v102, v98, v114
    v_dot2_f32_bf16 v115, v103, v98, v115
    s_waitcnt vmcnt(1)
    v_lshlrev_b32 v108, 16, v62
    v_and_b32 v109, s3, v62
    v_lshlrev_b32 v110, 16, v63
    v_and_b32 v111, s3, v63
    s_cmp_lg_u32 s6, 0
    v_mul_f32 v108, v108, v112
    v_mul_f32 v109, v109, v113
    v_mul_f32 v110, v110, v114
    v_mul_f32 v111, v111, v115
    s_cbranch_scc1 P2_FL13
    v_cvt_rpi_i32_f32 v112, v108
    ds_add_u32 v94, v112 offset:0
    v_cvt_rpi_i32_f32 v113, v109
    ds_add_u32 v94, v113 offset:6272
    v_cvt_rpi_i32_f32 v114, v110
    ds_add_u32 v94, v114 offset:12544
    v_cvt_rpi_i32_f32 v115, v111
    ds_add_u32 v94, v115 offset:18816
    s_branch P2_SK13
P2_FL13:
    ds_add_f32 v94, v108 offset:0
    ds_add_f32 v94, v109 offset:6272
    ds_add_f32 v94, v110 offset:12544
    ds_add_f32 v94, v111 offset:18816
P2_SK13:
    s_mov_b64 exec, -1
    s_waitcnt vmcnt(1)
    s_sub_i32 s14, s89, 7168
    s_max_i32 s14, s14, 0
    s_bfm_b64 exec, s14, 0
    s_cmp_ge_i32 s14, 64
    s_cselect_b64 exec, -1, exec
    v_mov_b32 v91, v67
    buffer_load_dwordx2 v[66:67], v66, s[20:23], 0 offen
    s_mov_b64 exec, -1
    s_sub_i32 s14, s89, 6144
    s_max_i32 s14, s14, 0
    s_bfm_b64 exec, s14, 0
    s_cmp_ge_i32 s14, 64
    s_cselect_b64 exec, -1, exec
    s_cbranch_execz P2_SK14
    v_and_b32 v94, 0xffff, v90
    v_add_u32 v93, v94, v94
    v_add_u32 v92, v93, v93
    ds_read_b64 v[104:105], v93 offset:25088
    ds_read_b128 v[100:103], v92 offset:37632
    v_and_b32 v95, s3, v90
    v_mul_f32 v96, 0.15915494, v95
    v_mul_f32 v97, 0x40400000, v95
    v_cos_f32 v96, v96
    v_cvt_pk_bf16_f32 v97, 0, v97
    v_mul_f32 v97, 0.15915494, v97
    v_mul_f32 v95, v96, v96
    v_cos_f32 v97, v97
    v_fma_f32 v95, v95, 2.0, -1.0
    v_cvt_pk_bf16_f32 v98, v96, v95
    v_cvt_pk_bf16_f32 v99, v97, 0
    v_cvt_pk_bf16_f32 v106, 0, v97
    s_waitcnt lgkmcnt(1)
    v_dot2_f32_bf16 v112, v104, v99, 0
    v_dot2_f32_bf16 v113, v104, v106, 0
    v_dot2_f32_bf16 v114, v105, v99, 0
    v_dot2_f32_bf16 v115, v105, v106, 0
    s_waitcnt lgkmcnt(0)
    v_dot2_f32_bf16 v112, v100, v98, v112
    v_dot2_f32_bf16 v113, v101, v98, v113
    v_dot2_f32_bf16 v114, v102, v98, v114
    v_dot2_f32_bf16 v115, v103, v98, v115
    s_waitcnt vmcnt(1)
    v_lshlrev_b32 v108, 16, v64
    v_and_b32 v109, s3, v64
    v_lshlrev_b32 v110, 16, v65
    v_and_b32 v111, s3, v65
    s_cmp_lg_u32 s6, 0
    v_mul_f32 v108, v108, v112
    v_mul_f32 v109, v109, v113
    v_mul_f32 v110, v110, v114
    v_mul_f32 v111, v111, v115
    s_cbranch_scc1 P2_FL14
    v_cvt_rpi_i32_f32 v112, v108
    ds_add_u32 v94, v112 offset:0
    v_cvt_rpi_i32_f32 v113, v109
    ds_add_u32 v94, v113 offset:6272
    v_cvt_rpi_i32_f32 v114, v110
    ds_add_u32 v94, v114 offset:12544
    v_cvt_rpi_i32_f32 v115, v111
    ds_add_u32 v94, v115 offset:18816
    s_branch P2_SK14
P2_FL14:
    ds_add_f32 v94, v108 offset:0
    ds_add_f32 v94, v109 offset:6272
    ds_add_f32 v94, v110 offset:12544
    ds_add_f32 v94, v111 offset:18816
P2_SK14:
    s_mov_b64 exec, -1
    s_waitcnt vmcnt(1)
    s_waitcnt lgkmcnt(0)
    s_barrier
    v_lshlrev_b32 v12, 2, v0
    v_cmp_gt_u32 vcc, 512, v0
    v_add_u32 v12, 62976, v12
    s_mov_b64 exec, vcc
    ds_write_b32 v12, v18
    s_mov_b64 exec, -1
    ds_read_b64 v[36:37], v13 offset:0
    ds_read_b64 v[38:39], v13 offset:8192
    ds_read_b64 v[40:41], v13 offset:16384
    ds_read_b64 v[42:43], v13 offset:24576
    ds_read_b64 v[44:45], v13 offset:32768
    ds_read_b64 v[46:47], v13 offset:40960
    ds_read_b64 v[48:49], v13 offset:49152
    ds_read_b64 v[50:51], v13 offset:57344
    s_waitcnt lgkmcnt(0)
    s_max_i32 s14, s88, 0
    s_bfm_b64 exec, s14, 0
    s_cmp_ge_i32 s14, 64
    s_cselect_b64 exec, -1, exec
    v_mov_b32 v76, v37
    buffer_load_dwordx2 v[36:37], v36, s[20:23], 0 offen
    s_mov_b64 exec, -1
    v_mov_b32 v114, 1
    s_mov_b32 s42, 60464
    s_max_i32 s14, s87, 0
    s_bfm_b64 exec, s14, 0
    s_cmp_ge_i32 s14, 64
    s_cselect_b64 exec, -1, exec
    v_lshrrev_b32 v12, 11, v20
    v_lshl_add_u32 v12, v12, 2, s42
    ds_add_rtn_u32 v68, v12, v114
    s_mov_b64 exec, -1
    s_sub_i32 s14, s87, 64
    s_max_i32 s14, s14, 0
    s_bfm_b64 exec, s14, 0
    s_cmp_ge_i32 s14, 64
    s_cselect_b64 exec, -1, exec
    v_lshrrev_b32 v12, 11, v22
    v_lshl_add_u32 v12, v12, 2, s42
    ds_add_rtn_u32 v69, v12, v114
    s_mov_b64 exec, -1
    s_sub_i32 s14, s87, 128
    s_max_i32 s14, s14, 0
    s_bfm_b64 exec, s14, 0
    s_cmp_ge_i32 s14, 64
    s_cselect_b64 exec, -1, exec
    v_lshrrev_b32 v12, 11, v24
    v_lshl_add_u32 v12, v12, 2, s42
    ds_add_rtn_u32 v70, v12, v114
    s_mov_b64 exec, -1
    s_sub_i32 s14, s87, 192
    s_max_i32 s14, s14, 0
    s_bfm_b64 exec, s14, 0
    s_cmp_ge_i32 s14, 64
    s_cselect_b64 exec, -1, exec
    v_lshrrev_b32 v12, 11, v26
    v_lshl_add_u32 v12, v12, 2, s42
    ds_add_rtn_u32 v71, v12, v114
    s_mov_b64 exec, -1
    s_sub_i32 s14, s87, 256
    s_max_i32 s14, s14, 0
    s_bfm_b64 exec, s14, 0
    s_cmp_ge_i32 s14, 64
    s_cselect_b64 exec, -1, exec
    v_lshrrev_b32 v12, 11, v28
    v_lshl_add_u32 v12, v12, 2, s42
    ds_add_rtn_u32 v72, v12, v114
    s_mov_b64 exec, -1
    s_sub_i32 s14, s87, 320
    s_max_i32 s14, s14, 0
    s_bfm_b64 exec, s14, 0
    s_cmp_ge_i32 s14, 64
    s_cselect_b64 exec, -1, exec
    v_lshrrev_b32 v12, 11, v30
    v_lshl_add_u32 v12, v12, 2, s42
    ds_add_rtn_u32 v73, v12, v114
    s_mov_b64 exec, -1
    s_sub_i32 s14, s87, 384
    s_max_i32 s14, s14, 0
    s_bfm_b64 exec, s14, 0
    s_cmp_ge_i32 s14, 64
    s_cselect_b64 exec, -1, exec
    v_lshrrev_b32 v12, 11, v32
    v_lshl_add_u32 v12, v12, 2, s42
    ds_add_rtn_u32 v74, v12, v114
    s_mov_b64 exec, -1
    s_sub_i32 s14, s87, 448
    s_max_i32 s14, s14, 0
    s_bfm_b64 exec, s14, 0
    s_cmp_ge_i32 s14, 64
    s_cselect_b64 exec, -1, exec
    v_lshrrev_b32 v12, 11, v34
    v_lshl_add_u32 v12, v12, 2, s42
    ds_add_rtn_u32 v75, v12, v114
    s_mov_b64 exec, -1
    s_waitcnt lgkmcnt(0)
    s_waitcnt lgkmcnt(0)
    s_barrier
    s_sub_i32 s14, s89, 7168
    s_max_i32 s14, s14, 0
    s_bfm_b64 exec, s14, 0
    s_cmp_ge_i32 s14, 64
    s_cselect_b64 exec, -1, exec
    s_cbranch_execz P2_SK15
    v_and_b32 v94, 0xffff, v91
    v_add_u32 v93, v94, v94
    v_add_u32 v92, v93, v93
    ds_read_b64 v[104:105], v93 offset:25088
    ds_read_b128 v[100:103], v92 offset:37632
    v_and_b32 v95, s3, v91
    v_mul_f32 v96, 0.15915494, v95
    v_mul_f32 v97, 0x40400000, v95
    v_cos_f32 v96, v96
    v_cvt_pk_bf16_f32 v97, 0, v97
    v_mul_f32 v97, 0.15915494, v97
    v_mul_f32 v95, v96, v96
    v_cos_f32 v97, v97
    v_fma_f32 v95, v95, 2.0, -1.0
    v_cvt_pk_bf16_f32 v98, v96, v95
    v_cvt_pk_bf16_f32 v99, v97, 0
    v_cvt_pk_bf16_f32 v106, 0, v97
    s_waitcnt lgkmcnt(1)
    v_dot2_f32_bf16 v112, v104, v99, 0
    v_dot2_f32_bf16 v113, v104, v106, 0
    v_dot2_f32_bf16 v114, v105, v99, 0
    v_dot2_f32_bf16 v115, v105, v106, 0
    s_waitcnt lgkmcnt(0)
    v_dot2_f32_bf16 v112, v100, v98, v112
    v_dot2_f32_bf16 v113, v101, v98, v113
    v_dot2_f32_bf16 v114, v102, v98, v114
    v_dot2_f32_bf16 v115, v103, v98, v115
    s_waitcnt vmcnt(1)
    v_lshlrev_b32 v108, 16, v66
    v_and_b32 v109, s3, v66
    v_lshlrev_b32 v110, 16, v67
    v_and_b32 v111, s3, v67
    s_cmp_lg_u32 s6, 0
    v_mul_f32 v108, v108, v112
    v_mul_f32 v109, v109, v113
    v_mul_f32 v110, v110, v114
    v_mul_f32 v111, v111, v115
    s_cbranch_scc1 P2_FL15
    v_cvt_rpi_i32_f32 v112, v108
    ds_add_u32 v94, v112 offset:0
    v_cvt_rpi_i32_f32 v113, v109
    ds_add_u32 v94, v113 offset:6272
    v_cvt_rpi_i32_f32 v114, v110
    ds_add_u32 v94, v114 offset:12544
    v_cvt_rpi_i32_f32 v115, v111
    ds_add_u32 v94, v115 offset:18816
    s_branch P2_SK15
P2_FL15:
    ds_add_f32 v94, v108 offset:0
    ds_add_f32 v94, v109 offset:6272
    ds_add_f32 v94, v110 offset:12544
    ds_add_f32 v94, v111 offset:18816
P2_SK15:
    s_mov_b64 exec, -1
    s_waitcnt vmcnt(1)
    s_sub_i32 s14, s88, 1024
    s_max_i32 s14, s14, 0
    s_bfm_b64 exec, s14, 0
    s_cmp_ge_i32 s14, 64
    s_cselect_b64 exec, -1, exec
    v_mov_b32 v77, v39
    buffer_load_dwordx2 v[38:39], v38, s[20:23], 0 offen
    s_mov_b64 exec, -1
    s_cmp_lg_u32 s5, 15
    s_cbranch_scc1 P2_NS16
    v_lshlrev_b32 v102, 2, v3
    v_add_u32 v102, 65024, v102
    ds_read_b128 v[92:95], v102
    ds_read_b128 v[96:99], v102 offset:16
    s_waitcnt lgkmcnt(0)
    v_add_u32 v93, v93, v92
    v_add_u32 v94, v94, v93
    v_add_u32 v95, v95, v94
    v_add_u32 v96, v96, v95
    v_add_u32 v97, v97, v96
    v_add_u32 v98, v98, v97
    v_add_u32 v99, v99, v98
    v_mov_b32 v100, v99
    s_nop 1
    v_add_u32_dpp v100, v100, v100 row_shr:1 row_mask:0xf bank_mask:0xf bound_ctrl:0
    s_nop 1
    v_add_u32_dpp v100, v100, v100 row_shr:2 row_mask:0xf bank_mask:0xf bound_ctrl:0
    s_nop 1
    v_add_u32_dpp v100, v100, v100 row_shr:4 row_mask:0xf bank_mask:0xf bound_ctrl:0
    s_nop 1
    v_add_u32_dpp v100, v100, v100 row_shr:8 row_mask:0xf bank_mask:0xf bound_ctrl:0
    s_nop 1
    v_add_u32_dpp v100, v100, v100 row_bcast:15 row_mask:0xa bank_mask:0xf
    s_nop 1
    v_add_u32_dpp v100, v100, v100 row_bcast:31 row_mask:0xc bank_mask:0xf
    s_nop 0
    v_readlane_b32 s14, v100, 63
    v_sub_u32 v100, v100, v99
    v_add_u32 v99, v98, v100
    v_add_u32 v98, v97, v100
    v_add_u32 v97, v96, v100
    v_add_u32 v96, v95, v100
    v_add_u32 v95, v94, v100
    v_add_u32 v94, v93, v100
    v_add_u32 v93, v92, v100
    v_mov_b32 v92, v100
    ds_write_b128 v102, v[92:95]
    ds_write_b128 v102, v[96:99] offset:16
    v_mov_b32 v101, s14
    v_mov_b32 v103, 62852
    ds_write_b32 v103, v101
    s_waitcnt lgkmcnt(0)
P2_NS16:
    s_max_i32 s14, s88, 0
    s_bfm_b64 exec, s14, 0
    s_cmp_ge_i32 s14, 64
    s_cselect_b64 exec, -1, exec
    s_cbranch_execz P2_SK17
    v_and_b32 v94, 0xffff, v76
    v_add_u32 v93, v94, v94
    v_add_u32 v92, v93, v93
    ds_read_b64 v[104:105], v93 offset:25088
    ds_read_b128 v[100:103], v92 offset:37632
    v_and_b32 v95, s3, v76
    v_mul_f32 v96, 0.15915494, v95
    v_mul_f32 v97, 0x40400000, v95
    v_cos_f32 v96, v96
    v_cvt_pk_bf16_f32 v97, 0, v97
    v_mul_f32 v97, 0.15915494, v97
    v_mul_f32 v95, v96, v96
    v_cos_f32 v97, v97
    v_fma_f32 v95, v95, 2.0, -1.0
    v_cvt_pk_bf16_f32 v98, v96, v95
    v_cvt_pk_bf16_f32 v99, v97, 0
    v_cvt_pk_bf16_f32 v106, 0, v97
    s_waitcnt lgkmcnt(1)
    v_dot2_f32_bf16 v112, v104, v99, 0
    v_dot2_f32_bf16 v113, v104, v106, 0
    v_dot2_f32_bf16 v114, v105, v99, 0
    v_dot2_f32_bf16 v115, v105, v106, 0
    s_waitcnt lgkmcnt(0)
    v_dot2_f32_bf16 v112, v100, v98, v112
    v_dot2_f32_bf16 v113, v101, v98, v113
    v_dot2_f32_bf16 v114, v102, v98, v114
    v_dot2_f32_bf16 v115, v103, v98, v115
    s_waitcnt vmcnt(1)
    v_lshlrev_b32 v108, 16, v36
    v_and_b32 v109, s3, v36
    v_lshlrev_b32 v110, 16, v37
    v_and_b32 v111, s3, v37
    s_cmp_lg_u32 s6, 0
    v_mul_f32 v108, v108, v112
    v_mul_f32 v109, v109, v113
    v_mul_f32 v110, v110, v114
    v_mul_f32 v111, v111, v115
    s_cbranch_scc1 P2_FL17
    v_cvt_rpi_i32_f32 v112, v108
    ds_add_u32 v94, v112 offset:0
    v_cvt_rpi_i32_f32 v113, v109
    ds_add_u32 v94, v113 offset:6272
    v_cvt_rpi_i32_f32 v114, v110
    ds_add_u32 v94, v114 offset:12544
    v_cvt_rpi_i32_f32 v115, v111
    ds_add_u32 v94, v115 offset:18816
    s_branch P2_SK17
P2_FL17:
    ds_add_f32 v94, v108 offset:0
    ds_add_f32 v94, v109 offset:6272
    ds_add_f32 v94, v110 offset:12544
    ds_add_f32 v94, v111 offset:18816
P2_SK17:
    s_mov_b64 exec, -1
    s_waitcnt vmcnt(1)
    s_sub_i32 s14, s88, 2048
    s_max_i32 s14, s14, 0
    s_bfm_b64 exec, s14, 0
    s_cmp_ge_i32 s14, 64
    s_cselect_b64 exec, -1, exec
    v_mov_b32 v78, v41
    buffer_load_dwordx2 v[40:41], v40, s[20:23], 0 offen
    s_mov_b64 exec, -1
    s_sub_i32 s14, s88, 1024
    s_max_i32 s14, s14, 0
    s_bfm_b64 exec, s14, 0
    s_cmp_ge_i32 s14, 64
    s_cselect_b64 exec, -1, exec
    s_cbranch_execz P2_SK18
    v_and_b32 v94, 0xffff, v77
    v_add_u32 v93, v94, v94
    v_add_u32 v92, v93, v93
    ds_read_b64 v[104:105], v93 offset:25088
    ds_read_b128 v[100:103], v92 offset:37632
    v_and_b32 v95, s3, v77
    v_mul_f32 v96, 0.15915494, v95
    v_mul_f32 v97, 0x40400000, v95
    v_cos_f32 v96, v96
    v_cvt_pk_bf16_f32 v97, 0, v97
    v_mul_f32 v97, 0.15915494, v97
    v_mul_f32 v95, v96, v96
    v_cos_f32 v97, v97
    v_fma_f32 v95, v95, 2.0, -1.0
    v_cvt_pk_bf16_f32 v98, v96, v95
    v_cvt_pk_bf16_f32 v99, v97, 0
    v_cvt_pk_bf16_f32 v106, 0, v97
    s_waitcnt lgkmcnt(1)
    v_dot2_f32_bf16 v112, v104, v99, 0
    v_dot2_f32_bf16 v113, v104, v106, 0
    v_dot2_f32_bf16 v114, v105, v99, 0
    v_dot2_f32_bf16 v115, v105, v106, 0
    s_waitcnt lgkmcnt(0)
    v_dot2_f32_bf16 v112, v100, v98, v112
    v_dot2_f32_bf16 v113, v101, v98, v113
    v_dot2_f32_bf16 v114, v102, v98, v114
    v_dot2_f32_bf16 v115, v103, v98, v115
    s_waitcnt vmcnt(1)
    v_lshlrev_b32 v108, 16, v38
    v_and_b32 v109, s3, v38
    v_lshlrev_b32 v110, 16, v39
    v_and_b32 v111, s3, v39
    s_cmp_lg_u32 s6, 0
    v_mul_f32 v108, v108, v112
    v_mul_f32 v109, v109, v113
    v_mul_f32 v110, v110, v114
    v_mul_f32 v111, v111, v115
    s_cbranch_scc1 P2_FL18
    v_cvt_rpi_i32_f32 v112, v108
    ds_add_u32 v94, v112 offset:0
    v_cvt_rpi_i32_f32 v113, v109
    ds_add_u32 v94, v113 offset:6272
    v_cvt_rpi_i32_f32 v114, v110
    ds_add_u32 v94, v114 offset:12544
    v_cvt_rpi_i32_f32 v115, v111
    ds_add_u32 v94, v115 offset:18816
    s_branch P2_SK18
P2_FL18:
    ds_add_f32 v94, v108 offset:0
    ds_add_f32 v94, v109 offset:6272
    ds_add_f32 v94, v110 offset:12544
    ds_add_f32 v94, v111 offset:18816
P2_SK18:
    s_mov_b64 exec, -1
    s_waitcnt vmcnt(1)
    s_sub_i32 s14, s88, 3072
    s_max_i32 s14, s14, 0
    s_bfm_b64 exec, s14, 0
    s_cmp_ge_i32 s14, 64
    s_cselect_b64 exec, -1, exec
    v_mov_b32 v79, v43
    buffer_load_dwordx2 v[42:43], v42, s[20:23], 0 offen
    s_mov_b64 exec, -1
    s_waitcnt lgkmcnt(0)
    s_barrier
    s_sub_i32 s14, s88, 2048
    s_max_i32 s14, s14, 0
    s_bfm_b64 exec, s14, 0
    s_cmp_ge_i32 s14, 64
    s_cselect_b64 exec, -1, exec
    s_cbranch_execz P2_SK19
    v_and_b32 v94, 0xffff, v78
    v_add_u32 v93, v94, v94
    v_add_u32 v92, v93, v93
    ds_read_b64 v[104:105], v93 offset:25088
    ds_read_b128 v[100:103], v92 offset:37632
    v_and_b32 v95, s3, v78
    v_mul_f32 v96, 0.15915494, v95
    v_mul_f32 v97, 0x40400000, v95
    v_cos_f32 v96, v96
    v_cvt_pk_bf16_f32 v97, 0, v97
    v_mul_f32 v97, 0.15915494, v97
    v_mul_f32 v95, v96, v96
    v_cos_f32 v97, v97
    v_fma_f32 v95, v95, 2.0, -1.0
    v_cvt_pk_bf16_f32 v98, v96, v95
    v_cvt_pk_bf16_f32 v99, v97, 0
    v_cvt_pk_bf16_f32 v106, 0, v97
    s_waitcnt lgkmcnt(1)
    v_dot2_f32_bf16 v112, v104, v99, 0
    v_dot2_f32_bf16 v113, v104, v106, 0
    v_dot2_f32_bf16 v114, v105, v99, 0
    v_dot2_f32_bf16 v115, v105, v106, 0
    s_waitcnt lgkmcnt(0)
    v_dot2_f32_bf16 v112, v100, v98, v112
    v_dot2_f32_bf16 v113, v101, v98, v113
    v_dot2_f32_bf16 v114, v102, v98, v114
    v_dot2_f32_bf16 v115, v103, v98, v115
    s_waitcnt vmcnt(1)
    v_lshlrev_b32 v108, 16, v40
    v_and_b32 v109, s3, v40
    v_lshlrev_b32 v110, 16, v41
    v_and_b32 v111, s3, v41
    s_cmp_lg_u32 s6, 0
    v_mul_f32 v108, v108, v112
    v_mul_f32 v109, v109, v113
    v_mul_f32 v110, v110, v114
    v_mul_f32 v111, v111, v115
    s_cbranch_scc1 P2_FL19
    v_cvt_rpi_i32_f32 v112, v108
    ds_add_u32 v94, v112 offset:0
    v_cvt_rpi_i32_f32 v113, v109
    ds_add_u32 v94, v113 offset:6272
    v_cvt_rpi_i32_f32 v114, v110
    ds_add_u32 v94, v114 offset:12544
    v_cvt_rpi_i32_f32 v115, v111
    ds_add_u32 v94, v115 offset:18816
    s_branch P2_SK19
P2_FL19:
    ds_add_f32 v94, v108 offset:0
    ds_add_f32 v94, v109 offset:6272
    ds_add_f32 v94, v110 offset:12544
    ds_add_f32 v94, v111 offset:18816
P2_SK19:
    s_mov_b64 exec, -1
    s_waitcnt vmcnt(1)
    s_sub_i32 s14, s88, 4096
    s_max_i32 s14, s14, 0
    s_bfm_b64 exec, s14, 0
    s_cmp_ge_i32 s14, 64
    s_cselect_b64 exec, -1, exec
    v_mov_b32 v80, v45
    buffer_load_dwordx2 v[44:45], v44, s[20:23], 0 offen
    s_mov_b64 exec, -1
    s_mov_b32 s42, 60464
    s_mov_b32 s43, 83456
    v_mov_b32 v100, 62852
    ds_read_b32 v100, v100
    v_lshrrev_b32 v102, 11, v20
    v_lshl_add_u32 v102, v102, 2, s42
    s_max_i32 s14, s87, 0
    s_bfm_b64 exec, s14, 0
    s_cmp_ge_i32 s14, 64
    s_cselect_b64 exec, -1, exec
    ds_read_b32 v102, v102
    s_mov_b64 exec, -1
    v_lshrrev_b32 v103, 11, v22
    v_lshl_add_u32 v103, v103, 2, s42
    s_sub_i32 s14, s87, 64
    s_max_i32 s14, s14, 0
    s_bfm_b64 exec, s14, 0
    s_cmp_ge_i32 s14, 64
    s_cselect_b64 exec, -1, exec
    ds_read_b32 v103, v103
    s_mov_b64 exec, -1
    v_lshrrev_b32 v104, 11, v24
    v_lshl_add_u32 v104, v104, 2, s42
    s_sub_i32 s14, s87, 128
    s_max_i32 s14, s14, 0
    s_bfm_b64 exec, s14, 0
    s_cmp_ge_i32 s14, 64
    s_cselect_b64 exec, -1, exec
    ds_read_b32 v104, v104
    s_mov_b64 exec, -1
    v_lshrrev_b32 v105, 11, v26
    v_lshl_add_u32 v105, v105, 2, s42
    s_sub_i32 s14, s87, 192
    s_max_i32 s14, s14, 0
    s_bfm_b64 exec, s14, 0
    s_cmp_ge_i32 s14, 64
    s_cselect_b64 exec, -1, exec
    ds_read_b32 v105, v105
    s_mov_b64 exec, -1
    v_lshrrev_b32 v106, 11, v28
    v_lshl_add_u32 v106, v106, 2, s42
    s_sub_i32 s14, s87, 256
    s_max_i32 s14, s14, 0
    s_bfm_b64 exec, s14, 0
    s_cmp_ge_i32 s14, 64
    s_cselect_b64 exec, -1, exec
    ds_read_b32 v106, v106
    s_mov_b64 exec, -1
    v_lshrrev_b32 v107, 11, v30
    v_lshl_add_u32 v107, v107, 2, s42
    s_sub_i32 s14, s87, 320
    s_max_i32 s14, s14, 0
    s_bfm_b64 exec, s14, 0
    s_cmp_ge_i32 s14, 64
    s_cselect_b64 exec, -1, exec
    ds_read_b32 v107, v107
    s_mov_b64 exec, -1
    v_lshrrev_b32 v108, 11, v32
    v_lshl_add_u32 v108, v108, 2, s42
    s_sub_i32 s14, s87, 384
    s_max_i32 s14, s14, 0
    s_bfm_b64 exec, s14, 0
    s_cmp_ge_i32 s14, 64
    s_cselect_b64 exec, -1, exec
    ds_read_b32 v108, v108
    s_mov_b64 exec, -1
    v_lshrrev_b32 v109, 11, v34
    v_lshl_add_u32 v109, v109, 2, s42
    s_sub_i32 s14, s87, 448
    s_max_i32 s14, s14, 0
    s_bfm_b64 exec, s14, 0
    s_cmp_ge_i32 s14, 64
    s_cselect_b64 exec, -1, exec
    ds_read_b32 v109, v109
    s_mov_b64 exec, -1
    s_waitcnt lgkmcnt(8)
    v_readfirstlane_b32 s89, v100
    s_lshl_b32 s15, s5, 6
    s_sub_i32 s89, s89, s15
    s_waitcnt lgkmcnt(7)
    v_add_u32 v102, v102, v68
    v_lshl_add_u32 v102, v102, 3, s43
    s_max_i32 s14, s87, 0
    s_bfm_b64 exec, s14, 0
    s_cmp_ge_i32 s14, 64
    s_cselect_b64 exec, -1, exec
    ds_write_b64 v102, v[20:21]
    s_mov_b64 exec, -1
    s_waitcnt lgkmcnt(7)
    v_add_u32 v103, v103, v69
    v_lshl_add_u32 v103, v103, 3, s43
    s_sub_i32 s14, s87, 64
    s_max_i32 s14, s14, 0
    s_bfm_b64 exec, s14, 0
    s_cmp_ge_i32 s14, 64
    s_cselect_b64 exec, -1, exec
    ds_write_b64 v103, v[22:23]
    s_mov_b64 exec, -1
    s_waitcnt lgkmcnt(7)
    v_add_u32 v104, v104, v70
    v_lshl_add_u32 v104, v104, 3, s43
    s_sub_i32 s14, s87, 128
    s_max_i32 s14, s14, 0
    s_bfm_b64 exec, s14, 0
    s_cmp_ge_i32 s14, 64
    s_cselect_b64 exec, -1, exec
    ds_write_b64 v104, v[24:25]
    s_mov_b64 exec, -1
    s_waitcnt lgkmcnt(7)
    v_add_u32 v105, v105, v71
    v_lshl_add_u32 v105, v105, 3, s43
    s_sub_i32 s14, s87, 192
    s_max_i32 s14, s14, 0
    s_bfm_b64 exec, s14, 0
    s_cmp_ge_i32 s14, 64
    s_cselect_b64 exec, -1, exec
    ds_write_b64 v105, v[26:27]
    s_mov_b64 exec, -1
    s_waitcnt lgkmcnt(7)
    v_add_u32 v106, v106, v72
    v_lshl_add_u32 v106, v106, 3, s43
    s_sub_i32 s14, s87, 256
    s_max_i32 s14, s14, 0
    s_bfm_b64 exec, s14, 0
    s_cmp_ge_i32 s14, 64
    s_cselect_b64 exec, -1, exec
    ds_write_b64 v106, v[28:29]
    s_mov_b64 exec, -1
    s_waitcnt lgkmcnt(7)
    v_add_u32 v107, v107, v73
    v_lshl_add_u32 v107, v107, 3, s43
    s_sub_i32 s14, s87, 320
    s_max_i32 s14, s14, 0
    s_bfm_b64 exec, s14, 0
    s_cmp_ge_i32 s14, 64
    s_cselect_b64 exec, -1, exec
    ds_write_b64 v107, v[30:31]
    s_mov_b64 exec, -1
    s_waitcnt lgkmcnt(7)
    v_add_u32 v108, v108, v74
    v_lshl_add_u32 v108, v108, 3, s43
    s_sub_i32 s14, s87, 384
    s_max_i32 s14, s14, 0
    s_bfm_b64 exec, s14, 0
    s_cmp_ge_i32 s14, 64
    s_cselect_b64 exec, -1, exec
    ds_write_b64 v108, v[32:33]
    s_mov_b64 exec, -1
    s_waitcnt lgkmcnt(7)
    v_add_u32 v109, v109, v75
    v_lshl_add_u32 v109, v109, 3, s43
    s_sub_i32 s14, s87, 448
    s_max_i32 s14, s14, 0
    s_bfm_b64 exec, s14, 0
    s_cmp_ge_i32 s14, 64
    s_cselect_b64 exec, -1, exec
    ds_write_b64 v109, v[34:35]
    s_mov_b64 exec, -1
    s_sub_i32 s14, s88, 3072
    s_max_i32 s14, s14, 0
    s_bfm_b64 exec, s14, 0
    s_cmp_ge_i32 s14, 64
    s_cselect_b64 exec, -1, exec
    s_cbranch_execz P2_SK20
    v_and_b32 v94, 0xffff, v79
    v_add_u32 v93, v94, v94
    v_add_u32 v92, v93, v93
    ds_read_b64 v[104:105], v93 offset:25088
    ds_read_b128 v[100:103], v92 offset:37632
    v_and_b32 v95, s3, v79
    v_mul_f32 v96, 0.15915494, v95
    v_mul_f32 v97, 0x40400000, v95
    v_cos_f32 v96, v96
    v_cvt_pk_bf16_f32 v97, 0, v97
    v_mul_f32 v97, 0.15915494, v97
    v_mul_f32 v95, v96, v96
    v_cos_f32 v97, v97
    v_fma_f32 v95, v95, 2.0, -1.0
    v_cvt_pk_bf16_f32 v98, v96, v95
    v_cvt_pk_bf16_f32 v99, v97, 0
    v_cvt_pk_bf16_f32 v106, 0, v97
    s_waitcnt lgkmcnt(1)
    v_dot2_f32_bf16 v112, v104, v99, 0
    v_dot2_f32_bf16 v113, v104, v106, 0
    v_dot2_f32_bf16 v114, v105, v99, 0
    v_dot2_f32_bf16 v115, v105, v106, 0
    s_waitcnt lgkmcnt(0)
    v_dot2_f32_bf16 v112, v100, v98, v112
    v_dot2_f32_bf16 v113, v101, v98, v113
    v_dot2_f32_bf16 v114, v102, v98, v114
    v_dot2_f32_bf16 v115, v103, v98, v115
    s_waitcnt vmcnt(1)
    v_lshlrev_b32 v108, 16, v42
    v_and_b32 v109, s3, v42
    v_lshlrev_b32 v110, 16, v43
    v_and_b32 v111, s3, v43
    s_cmp_lg_u32 s6, 0
    v_mul_f32 v108, v108, v112
    v_mul_f32 v109, v109, v113
    v_mul_f32 v110, v110, v114
    v_mul_f32 v111, v111, v115
    s_cbranch_scc1 P2_FL20
    v_cvt_rpi_i32_f32 v112, v108
    ds_add_u32 v94, v112 offset:0
    v_cvt_rpi_i32_f32 v113, v109
    ds_add_u32 v94, v113 offset:6272
    v_cvt_rpi_i32_f32 v114, v110
    ds_add_u32 v94, v114 offset:12544
    v_cvt_rpi_i32_f32 v115, v111
    ds_add_u32 v94, v115 offset:18816
    s_branch P2_SK20
P2_FL20:
    ds_add_f32 v94, v108 offset:0
    ds_add_f32 v94, v109 offset:6272
    ds_add_f32 v94, v110 offset:12544
    ds_add_f32 v94, v111 offset:18816
P2_SK20:
    s_mov_b64 exec, -1
    s_waitcnt vmcnt(1)
    s_sub_i32 s14, s88, 5120
    s_max_i32 s14, s14, 0
    s_bfm_b64 exec, s14, 0
    s_cmp_ge_i32 s14, 64
    s_cselect_b64 exec, -1, exec
    v_mov_b32 v81, v47
    buffer_load_dwordx2 v[46:47], v46, s[20:23], 0 offen
    s_mov_b64 exec, -1
    s_sub_i32 s14, s88, 4096
    s_max_i32 s14, s14, 0
    s_bfm_b64 exec, s14, 0
    s_cmp_ge_i32 s14, 64
    s_cselect_b64 exec, -1, exec
    s_cbranch_execz P2_SK21
    v_and_b32 v94, 0xffff, v80
    v_add_u32 v93, v94, v94
    v_add_u32 v92, v93, v93
    ds_read_b64 v[104:105], v93 offset:25088
    ds_read_b128 v[100:103], v92 offset:37632
    v_and_b32 v95, s3, v80
    v_mul_f32 v96, 0.15915494, v95
    v_mul_f32 v97, 0x40400000, v95
    v_cos_f32 v96, v96
    v_cvt_pk_bf16_f32 v97, 0, v97
    v_mul_f32 v97, 0.15915494, v97
    v_mul_f32 v95, v96, v96
    v_cos_f32 v97, v97
    v_fma_f32 v95, v95, 2.0, -1.0
    v_cvt_pk_bf16_f32 v98, v96, v95
    v_cvt_pk_bf16_f32 v99, v97, 0
    v_cvt_pk_bf16_f32 v106, 0, v97
    s_waitcnt lgkmcnt(1)
    v_dot2_f32_bf16 v112, v104, v99, 0
    v_dot2_f32_bf16 v113, v104, v106, 0
    v_dot2_f32_bf16 v114, v105, v99, 0
    v_dot2_f32_bf16 v115, v105, v106, 0
    s_waitcnt lgkmcnt(0)
    v_dot2_f32_bf16 v112, v100, v98, v112
    v_dot2_f32_bf16 v113, v101, v98, v113
    v_dot2_f32_bf16 v114, v102, v98, v114
    v_dot2_f32_bf16 v115, v103, v98, v115
    s_waitcnt vmcnt(1)
    v_lshlrev_b32 v108, 16, v44
    v_and_b32 v109, s3, v44
    v_lshlrev_b32 v110, 16, v45
    v_and_b32 v111, s3, v45
    s_cmp_lg_u32 s6, 0
    v_mul_f32 v108, v108, v112
    v_mul_f32 v109, v109, v113
    v_mul_f32 v110, v110, v114
    v_mul_f32 v111, v111, v115
    s_cbranch_scc1 P2_FL21
    v_cvt_rpi_i32_f32 v112, v108
    ds_add_u32 v94, v112 offset:0
    v_cvt_rpi_i32_f32 v113, v109
    ds_add_u32 v94, v113 offset:6272
    v_cvt_rpi_i32_f32 v114, v110
    ds_add_u32 v94, v114 offset:12544
    v_cvt_rpi_i32_f32 v115, v111
    ds_add_u32 v94, v115 offset:18816
    s_branch P2_SK21
P2_FL21:
    ds_add_f32 v94, v108 offset:0
    ds_add_f32 v94, v109 offset:6272
    ds_add_f32 v94, v110 offset:12544
    ds_add_f32 v94, v111 offset:18816
P2_SK21:
    s_mov_b64 exec, -1
    s_waitcnt vmcnt(1)
    s_sub_i32 s14, s88, 6144
    s_max_i32 s14, s14, 0
    s_bfm_b64 exec, s14, 0
    s_cmp_ge_i32 s14, 64
    s_cselect_b64 exec, -1, exec
    v_mov_b32 v82, v49
    buffer_load_dwordx2 v[48:49], v48, s[20:23], 0 offen
    s_mov_b64 exec, -1
    s_sub_i32 s14, s88, 5120
    s_max_i32 s14, s14, 0
    s_bfm_b64 exec, s14, 0
    s_cmp_ge_i32 s14, 64
    s_cselect_b64 exec, -1, exec
    s_cbranch_execz P2_SK22
    v_and_b32 v94, 0xffff, v81
    v_add_u32 v93, v94, v94
    v_add_u32 v92, v93, v93
    ds_read_b64 v[104:105], v93 offset:25088
    ds_read_b128 v[100:103], v92 offset:37632
    v_and_b32 v95, s3, v81
    v_mul_f32 v96, 0.15915494, v95
    v_mul_f32 v97, 0x40400000, v95
    v_cos_f32 v96, v96
    v_cvt_pk_bf16_f32 v97, 0, v97
    v_mul_f32 v97, 0.15915494, v97
    v_mul_f32 v95, v96, v96
    v_cos_f32 v97, v97
    v_fma_f32 v95, v95, 2.0, -1.0
    v_cvt_pk_bf16_f32 v98, v96, v95
    v_cvt_pk_bf16_f32 v99, v97, 0
    v_cvt_pk_bf16_f32 v106, 0, v97
    s_waitcnt lgkmcnt(1)
    v_dot2_f32_bf16 v112, v104, v99, 0
    v_dot2_f32_bf16 v113, v104, v106, 0
    v_dot2_f32_bf16 v114, v105, v99, 0
    v_dot2_f32_bf16 v115, v105, v106, 0
    s_waitcnt lgkmcnt(0)
    v_dot2_f32_bf16 v112, v100, v98, v112
    v_dot2_f32_bf16 v113, v101, v98, v113
    v_dot2_f32_bf16 v114, v102, v98, v114
    v_dot2_f32_bf16 v115, v103, v98, v115
    s_waitcnt vmcnt(1)
    v_lshlrev_b32 v108, 16, v46
    v_and_b32 v109, s3, v46
    v_lshlrev_b32 v110, 16, v47
    v_and_b32 v111, s3, v47
    s_cmp_lg_u32 s6, 0
    v_mul_f32 v108, v108, v112
    v_mul_f32 v109, v109, v113
    v_mul_f32 v110, v110, v114
    v_mul_f32 v111, v111, v115
    s_cbranch_scc1 P2_FL22
    v_cvt_rpi_i32_f32 v112, v108
    ds_add_u32 v94, v112 offset:0
    v_cvt_rpi_i32_f32 v113, v109
    ds_add_u32 v94, v113 offset:6272
    v_cvt_rpi_i32_f32 v114, v110
    ds_add_u32 v94, v114 offset:12544
    v_cvt_rpi_i32_f32 v115, v111
    ds_add_u32 v94, v115 offset:18816
    s_branch P2_SK22
P2_FL22:
    ds_add_f32 v94, v108 offset:0
    ds_add_f32 v94, v109 offset:6272
    ds_add_f32 v94, v110 offset:12544
    ds_add_f32 v94, v111 offset:18816
P2_SK22:
    s_mov_b64 exec, -1
    s_waitcnt vmcnt(1)
    s_sub_i32 s14, s88, 7168
    s_max_i32 s14, s14, 0
    s_bfm_b64 exec, s14, 0
    s_cmp_ge_i32 s14, 64
    s_cselect_b64 exec, -1, exec
    v_mov_b32 v83, v51
    buffer_load_dwordx2 v[50:51], v50, s[20:23], 0 offen
    s_mov_b64 exec, -1
    s_sub_i32 s14, s88, 6144
    s_max_i32 s14, s14, 0
    s_bfm_b64 exec, s14, 0
    s_cmp_ge_i32 s14, 64
    s_cselect_b64 exec, -1, exec
    s_cbranch_execz P2_SK23
    v_and_b32 v94, 0xffff, v82
    v_add_u32 v93, v94, v94
    v_add_u32 v92, v93, v93
    ds_read_b64 v[104:105], v93 offset:25088
    ds_read_b128 v[100:103], v92 offset:37632
    v_and_b32 v95, s3, v82
    v_mul_f32 v96, 0.15915494, v95
    v_mul_f32 v97, 0x40400000, v95
    v_cos_f32 v96, v96
    v_cvt_pk_bf16_f32 v97, 0, v97
    v_mul_f32 v97, 0.15915494, v97
    v_mul_f32 v95, v96, v96
    v_cos_f32 v97, v97
    v_fma_f32 v95, v95, 2.0, -1.0
    v_cvt_pk_bf16_f32 v98, v96, v95
    v_cvt_pk_bf16_f32 v99, v97, 0
    v_cvt_pk_bf16_f32 v106, 0, v97
    s_waitcnt lgkmcnt(1)
    v_dot2_f32_bf16 v112, v104, v99, 0
    v_dot2_f32_bf16 v113, v104, v106, 0
    v_dot2_f32_bf16 v114, v105, v99, 0
    v_dot2_f32_bf16 v115, v105, v106, 0
    s_waitcnt lgkmcnt(0)
    v_dot2_f32_bf16 v112, v100, v98, v112
    v_dot2_f32_bf16 v113, v101, v98, v113
    v_dot2_f32_bf16 v114, v102, v98, v114
    v_dot2_f32_bf16 v115, v103, v98, v115
    s_waitcnt vmcnt(1)
    v_lshlrev_b32 v108, 16, v48
    v_and_b32 v109, s3, v48
    v_lshlrev_b32 v110, 16, v49
    v_and_b32 v111, s3, v49
    s_cmp_lg_u32 s6, 0
    v_mul_f32 v108, v108, v112
    v_mul_f32 v109, v109, v113
    v_mul_f32 v110, v110, v114
    v_mul_f32 v111, v111, v115
    s_cbranch_scc1 P2_FL23
    v_cvt_rpi_i32_f32 v112, v108
    ds_add_u32 v94, v112 offset:0
    v_cvt_rpi_i32_f32 v113, v109
    ds_add_u32 v94, v113 offset:6272
    v_cvt_rpi_i32_f32 v114, v110
    ds_add_u32 v94, v114 offset:12544
    v_cvt_rpi_i32_f32 v115, v111
    ds_add_u32 v94, v115 offset:18816
    s_branch P2_SK23
P2_FL23:
    ds_add_f32 v94, v108 offset:0
    ds_add_f32 v94, v109 offset:6272
    ds_add_f32 v94, v110 offset:12544
    ds_add_f32 v94, v111 offset:18816
P2_SK23:
    s_mov_b64 exec, -1
    s_waitcnt vmcnt(1)
    s_waitcnt lgkmcnt(0)
    s_barrier
    v_lshlrev_b32 v12, 2, v0
    v_cmp_gt_u32 vcc, 512, v0
    v_add_u32 v12, 65024, v12
    s_mov_b64 exec, vcc
    ds_write_b32 v12, v18
    s_mov_b64 exec, -1
    ds_read_b64 v[52:53], v13 offset:0
    ds_read_b64 v[54:55], v13 offset:8192
    ds_read_b64 v[56:57], v13 offset:16384
    ds_read_b64 v[58:59], v13 offset:24576
    ds_read_b64 v[60:61], v13 offset:32768
    ds_read_b64 v[62:63], v13 offset:40960
    ds_read_b64 v[64:65], v13 offset:49152
    ds_read_b64 v[66:67], v13 offset:57344
    s_waitcnt lgkmcnt(0)
    s_max_i32 s14, s89, 0
    s_bfm_b64 exec, s14, 0
    s_cmp_ge_i32 s14, 64
    s_cselect_b64 exec, -1, exec
    v_mov_b32 v84, v53
    buffer_load_dwordx2 v[52:53], v52, s[20:23], 0 offen
    s_mov_b64 exec, -1
    s_sub_i32 s14, s88, 7168
    s_max_i32 s14, s14, 0
    s_bfm_b64 exec, s14, 0
    s_cmp_ge_i32 s14, 64
    s_cselect_b64 exec, -1, exec
    s_cbranch_execz P2_SK24
    v_and_b32 v94, 0xffff, v83
    v_add_u32 v93, v94, v94
    v_add_u32 v92, v93, v93
    ds_read_b64 v[104:105], v93 offset:25088
    ds_read_b128 v[100:103], v92 offset:37632
    v_and_b32 v95, s3, v83
    v_mul_f32 v96, 0.15915494, v95
    v_mul_f32 v97, 0x40400000, v95
    v_cos_f32 v96, v96
    v_cvt_pk_bf16_f32 v97, 0, v97
    v_mul_f32 v97, 0.15915494, v97
    v_mul_f32 v95, v96, v96
    v_cos_f32 v97, v97
    v_fma_f32 v95, v95, 2.0, -1.0
    v_cvt_pk_bf16_f32 v98, v96, v95
    v_cvt_pk_bf16_f32 v99, v97, 0
    v_cvt_pk_bf16_f32 v106, 0, v97
    s_waitcnt lgkmcnt(1)
    v_dot2_f32_bf16 v112, v104, v99, 0
    v_dot2_f32_bf16 v113, v104, v106, 0
    v_dot2_f32_bf16 v114, v105, v99, 0
    v_dot2_f32_bf16 v115, v105, v106, 0
    s_waitcnt lgkmcnt(0)
    v_dot2_f32_bf16 v112, v100, v98, v112
    v_dot2_f32_bf16 v113, v101, v98, v113
    v_dot2_f32_bf16 v114, v102, v98, v114
    v_dot2_f32_bf16 v115, v103, v98, v115
    s_waitcnt vmcnt(1)
    v_lshlrev_b32 v108, 16, v50
    v_and_b32 v109, s3, v50
    v_lshlrev_b32 v110, 16, v51
    v_and_b32 v111, s3, v51
    s_cmp_lg_u32 s6, 0
    v_mul_f32 v108, v108, v112
    v_mul_f32 v109, v109, v113
    v_mul_f32 v110, v110, v114
    v_mul_f32 v111, v111, v115
    s_cbranch_scc1 P2_FL24
    v_cvt_rpi_i32_f32 v112, v108
    ds_add_u32 v94, v112 offset:0
    v_cvt_rpi_i32_f32 v113, v109
    ds_add_u32 v94, v113 offset:6272
    v_cvt_rpi_i32_f32 v114, v110
    ds_add_u32 v94, v114 offset:12544
    v_cvt_rpi_i32_f32 v115, v111
    ds_add_u32 v94, v115 offset:18816
    s_branch P2_SK24
P2_FL24:
    ds_add_f32 v94, v108 offset:0
    ds_add_f32 v94, v109 offset:6272
    ds_add_f32 v94, v110 offset:12544
    ds_add_f32 v94, v111 offset:18816
P2_SK24:
    s_mov_b64 exec, -1
    s_waitcnt vmcnt(1)
    s_sub_i32 s14, s89, 1024
    s_max_i32 s14, s14, 0
    s_bfm_b64 exec, s14, 0
    s_cmp_ge_i32 s14, 64
    s_cselect_b64 exec, -1, exec
    v_mov_b32 v85, v55
    buffer_load_dwordx2 v[54:55], v54, s[20:23], 0 offen
    s_mov_b64 exec, -1
    s_max_i32 s14, s89, 0
    s_bfm_b64 exec, s14, 0
    s_cmp_ge_i32 s14, 64
    s_cselect_b64 exec, -1, exec
    s_cbranch_execz P2_SK25
    v_and_b32 v94, 0xffff, v84
    v_add_u32 v93, v94, v94
    v_add_u32 v92, v93, v93
    ds_read_b64 v[104:105], v93 offset:25088
    ds_read_b128 v[100:103], v92 offset:37632
    v_and_b32 v95, s3, v84
    v_mul_f32 v96, 0.15915494, v95
    v_mul_f32 v97, 0x40400000, v95
    v_cos_f32 v96, v96
    v_cvt_pk_bf16_f32 v97, 0, v97
    v_mul_f32 v97, 0.15915494, v97
    v_mul_f32 v95, v96, v96
    v_cos_f32 v97, v97
    v_fma_f32 v95, v95, 2.0, -1.0
    v_cvt_pk_bf16_f32 v98, v96, v95
    v_cvt_pk_bf16_f32 v99, v97, 0
    v_cvt_pk_bf16_f32 v106, 0, v97
    s_waitcnt lgkmcnt(1)
    v_dot2_f32_bf16 v112, v104, v99, 0
    v_dot2_f32_bf16 v113, v104, v106, 0
    v_dot2_f32_bf16 v114, v105, v99, 0
    v_dot2_f32_bf16 v115, v105, v106, 0
    s_waitcnt lgkmcnt(0)
    v_dot2_f32_bf16 v112, v100, v98, v112
    v_dot2_f32_bf16 v113, v101, v98, v113
    v_dot2_f32_bf16 v114, v102, v98, v114
    v_dot2_f32_bf16 v115, v103, v98, v115
    s_waitcnt vmcnt(1)
    v_lshlrev_b32 v108, 16, v52
    v_and_b32 v109, s3, v52
    v_lshlrev_b32 v110, 16, v53
    v_and_b32 v111, s3, v53
    s_cmp_lg_u32 s6, 0
    v_mul_f32 v108, v108, v112
    v_mul_f32 v109, v109, v113
    v_mul_f32 v110, v110, v114
    v_mul_f32 v111, v111, v115
    s_cbranch_scc1 P2_FL25
    v_cvt_rpi_i32_f32 v112, v108
    ds_add_u32 v94, v112 offset:0
    v_cvt_rpi_i32_f32 v113, v109
    ds_add_u32 v94, v113 offset:6272
    v_cvt_rpi_i32_f32 v114, v110
    ds_add_u32 v94, v114 offset:12544
    v_cvt_rpi_i32_f32 v115, v111
    ds_add_u32 v94, v115 offset:18816
    s_branch P2_SK25
P2_FL25:
    ds_add_f32 v94, v108 offset:0
    ds_add_f32 v94, v109 offset:6272
    ds_add_f32 v94, v110 offset:12544
    ds_add_f32 v94, v111 offset:18816
P2_SK25:
    s_mov_b64 exec, -1
    s_waitcnt vmcnt(1)
    s_sub_i32 s14, s89, 2048
    s_max_i32 s14, s14, 0
    s_bfm_b64 exec, s14, 0
    s_cmp_ge_i32 s14, 64
    s_cselect_b64 exec, -1, exec
    v_mov_b32 v86, v57
    buffer_load_dwordx2 v[56:57], v56, s[20:23], 0 offen
    s_mov_b64 exec, -1
    s_sub_i32 s14, s89, 1024
    s_max_i32 s14, s14, 0
    s_bfm_b64 exec, s14, 0
    s_cmp_ge_i32 s14, 64
    s_cselect_b64 exec, -1, exec
    s_cbranch_execz P2_SK26
    v_and_b32 v94, 0xffff, v85
    v_add_u32 v93, v94, v94
    v_add_u32 v92, v93, v93
    ds_read_b64 v[104:105], v93 offset:25088
    ds_read_b128 v[100:103], v92 offset:37632
    v_and_b32 v95, s3, v85
    v_mul_f32 v96, 0.15915494, v95
    v_mul_f32 v97, 0x40400000, v95
    v_cos_f32 v96, v96
    v_cvt_pk_bf16_f32 v97, 0, v97
    v_mul_f32 v97, 0.15915494, v97
    v_mul_f32 v95, v96, v96
    v_cos_f32 v97, v97
    v_fma_f32 v95, v95, 2.0, -1.0
    v_cvt_pk_bf16_f32 v98, v96, v95
    v_cvt_pk_bf16_f32 v99, v97, 0
    v_cvt_pk_bf16_f32 v106, 0, v97
    s_waitcnt lgkmcnt(1)
    v_dot2_f32_bf16 v112, v104, v99, 0
    v_dot2_f32_bf16 v113, v104, v106, 0
    v_dot2_f32_bf16 v114, v105, v99, 0
    v_dot2_f32_bf16 v115, v105, v106, 0
    s_waitcnt lgkmcnt(0)
    v_dot2_f32_bf16 v112, v100, v98, v112
    v_dot2_f32_bf16 v113, v101, v98, v113
    v_dot2_f32_bf16 v114, v102, v98, v114
    v_dot2_f32_bf16 v115, v103, v98, v115
    s_waitcnt vmcnt(1)
    v_lshlrev_b32 v108, 16, v54
    v_and_b32 v109, s3, v54
    v_lshlrev_b32 v110, 16, v55
    v_and_b32 v111, s3, v55
    s_cmp_lg_u32 s6, 0
    v_mul_f32 v108, v108, v112
    v_mul_f32 v109, v109, v113
    v_mul_f32 v110, v110, v114
    v_mul_f32 v111, v111, v115
    s_cbranch_scc1 P2_FL26
    v_cvt_rpi_i32_f32 v112, v108
    ds_add_u32 v94, v112 offset:0
    v_cvt_rpi_i32_f32 v113, v109
    ds_add_u32 v94, v113 offset:6272
    v_cvt_rpi_i32_f32 v114, v110
    ds_add_u32 v94, v114 offset:12544
    v_cvt_rpi_i32_f32 v115, v111
    ds_add_u32 v94, v115 offset:18816
    s_branch P2_SK26
P2_FL26:
    ds_add_f32 v94, v108 offset:0
    ds_add_f32 v94, v109 offset:6272
    ds_add_f32 v94, v110 offset:12544
    ds_add_f32 v94, v111 offset:18816
P2_SK26:
    s_mov_b64 exec, -1
    s_waitcnt vmcnt(1)
    s_sub_i32 s14, s89, 3072
    s_max_i32 s14, s14, 0
    s_bfm_b64 exec, s14, 0
    s_cmp_ge_i32 s14, 64
    s_cselect_b64 exec, -1, exec
    v_mov_b32 v87, v59
    buffer_load_dwordx2 v[58:59], v58, s[20:23], 0 offen
    s_mov_b64 exec, -1
    s_sub_i32 s14, s89, 2048
    s_max_i32 s14, s14, 0
    s_bfm_b64 exec, s14, 0
    s_cmp_ge_i32 s14, 64
    s_cselect_b64 exec, -1, exec
    s_cbranch_execz P2_SK27
    v_and_b32 v94, 0xffff, v86
    v_add_u32 v93, v94, v94
    v_add_u32 v92, v93, v93
    ds_read_b64 v[104:105], v93 offset:25088
    ds_read_b128 v[100:103], v92 offset:37632
    v_and_b32 v95, s3, v86
    v_mul_f32 v96, 0.15915494, v95
    v_mul_f32 v97, 0x40400000, v95
    v_cos_f32 v96, v96
    v_cvt_pk_bf16_f32 v97, 0, v97
    v_mul_f32 v97, 0.15915494, v97
    v_mul_f32 v95, v96, v96
    v_cos_f32 v97, v97
    v_fma_f32 v95, v95, 2.0, -1.0
    v_cvt_pk_bf16_f32 v98, v96, v95
    v_cvt_pk_bf16_f32 v99, v97, 0
    v_cvt_pk_bf16_f32 v106, 0, v97
    s_waitcnt lgkmcnt(1)
    v_dot2_f32_bf16 v112, v104, v99, 0
    v_dot2_f32_bf16 v113, v104, v106, 0
    v_dot2_f32_bf16 v114, v105, v99, 0
    v_dot2_f32_bf16 v115, v105, v106, 0
    s_waitcnt lgkmcnt(0)
    v_dot2_f32_bf16 v112, v100, v98, v112
    v_dot2_f32_bf16 v113, v101, v98, v113
    v_dot2_f32_bf16 v114, v102, v98, v114
    v_dot2_f32_bf16 v115, v103, v98, v115
    s_waitcnt vmcnt(1)
    v_lshlrev_b32 v108, 16, v56
    v_and_b32 v109, s3, v56
    v_lshlrev_b32 v110, 16, v57
    v_and_b32 v111, s3, v57
    s_cmp_lg_u32 s6, 0
    v_mul_f32 v108, v108, v112
    v_mul_f32 v109, v109, v113
    v_mul_f32 v110, v110, v114
    v_mul_f32 v111, v111, v115
    s_cbranch_scc1 P2_FL27
    v_cvt_rpi_i32_f32 v112, v108
    ds_add_u32 v94, v112 offset:0
    v_cvt_rpi_i32_f32 v113, v109
    ds_add_u32 v94, v113 offset:6272
    v_cvt_rpi_i32_f32 v114, v110
    ds_add_u32 v94, v114 offset:12544
    v_cvt_rpi_i32_f32 v115, v111
    ds_add_u32 v94, v115 offset:18816
    s_branch P2_SK27
P2_FL27:
    ds_add_f32 v94, v108 offset:0
    ds_add_f32 v94, v109 offset:6272
    ds_add_f32 v94, v110 offset:12544
    ds_add_f32 v94, v111 offset:18816
P2_SK27:
    s_mov_b64 exec, -1
    s_waitcnt vmcnt(1)
    s_sub_i32 s14, s89, 4096
    s_max_i32 s14, s14, 0
    s_bfm_b64 exec, s14, 0
    s_cmp_ge_i32 s14, 64
    s_cselect_b64 exec, -1, exec
    v_mov_b32 v88, v61
    buffer_load_dwordx2 v[60:61], v60, s[20:23], 0 offen
    s_mov_b64 exec, -1
    s_sub_i32 s14, s89, 3072
    s_max_i32 s14, s14, 0
    s_bfm_b64 exec, s14, 0
    s_cmp_ge_i32 s14, 64
    s_cselect_b64 exec, -1, exec
    s_cbranch_execz P2_SK28
    v_and_b32 v94, 0xffff, v87
    v_add_u32 v93, v94, v94
    v_add_u32 v92, v93, v93
    ds_read_b64 v[104:105], v93 offset:25088
    ds_read_b128 v[100:103], v92 offset:37632
    v_and_b32 v95, s3, v87
    v_mul_f32 v96, 0.15915494, v95
    v_mul_f32 v97, 0x40400000, v95
    v_cos_f32 v96, v96
    v_cvt_pk_bf16_f32 v97, 0, v97
    v_mul_f32 v97, 0.15915494, v97
    v_mul_f32 v95, v96, v96
    v_cos_f32 v97, v97
    v_fma_f32 v95, v95, 2.0, -1.0
    v_cvt_pk_bf16_f32 v98, v96, v95
    v_cvt_pk_bf16_f32 v99, v97, 0
    v_cvt_pk_bf16_f32 v106, 0, v97
    s_waitcnt lgkmcnt(1)
    v_dot2_f32_bf16 v112, v104, v99, 0
    v_dot2_f32_bf16 v113, v104, v106, 0
    v_dot2_f32_bf16 v114, v105, v99, 0
    v_dot2_f32_bf16 v115, v105, v106, 0
    s_waitcnt lgkmcnt(0)
    v_dot2_f32_bf16 v112, v100, v98, v112
    v_dot2_f32_bf16 v113, v101, v98, v113
    v_dot2_f32_bf16 v114, v102, v98, v114
    v_dot2_f32_bf16 v115, v103, v98, v115
    s_waitcnt vmcnt(1)
    v_lshlrev_b32 v108, 16, v58
    v_and_b32 v109, s3, v58
    v_lshlrev_b32 v110, 16, v59
    v_and_b32 v111, s3, v59
    s_cmp_lg_u32 s6, 0
    v_mul_f32 v108, v108, v112
    v_mul_f32 v109, v109, v113
    v_mul_f32 v110, v110, v114
    v_mul_f32 v111, v111, v115
    s_cbranch_scc1 P2_FL28
    v_cvt_rpi_i32_f32 v112, v108
    ds_add_u32 v94, v112 offset:0
    v_cvt_rpi_i32_f32 v113, v109
    ds_add_u32 v94, v113 offset:6272
    v_cvt_rpi_i32_f32 v114, v110
    ds_add_u32 v94, v114 offset:12544
    v_cvt_rpi_i32_f32 v115, v111
    ds_add_u32 v94, v115 offset:18816
    s_branch P2_SK28
P2_FL28:
    ds_add_f32 v94, v108 offset:0
    ds_add_f32 v94, v109 offset:6272
    ds_add_f32 v94, v110 offset:12544
    ds_add_f32 v94, v111 offset:18816
P2_SK28:
    s_mov_b64 exec, -1
    s_waitcnt vmcnt(1)
    s_sub_i32 s14, s89, 5120
    s_max_i32 s14, s14, 0
    s_bfm_b64 exec, s14, 0
    s_cmp_ge_i32 s14, 64
    s_cselect_b64 exec, -1, exec
    v_mov_b32 v89, v63
    buffer_load_dwordx2 v[62:63], v62, s[20:23], 0 offen
    s_mov_b64 exec, -1
    s_sub_i32 s14, s89, 4096
    s_max_i32 s14, s14, 0
    s_bfm_b64 exec, s14, 0
    s_cmp_ge_i32 s14, 64
    s_cselect_b64 exec, -1, exec
    s_cbranch_execz P2_SK29
    v_and_b32 v94, 0xffff, v88
    v_add_u32 v93, v94, v94
    v_add_u32 v92, v93, v93
    ds_read_b64 v[104:105], v93 offset:25088
    ds_read_b128 v[100:103], v92 offset:37632
    v_and_b32 v95, s3, v88
    v_mul_f32 v96, 0.15915494, v95
    v_mul_f32 v97, 0x40400000, v95
    v_cos_f32 v96, v96
    v_cvt_pk_bf16_f32 v97, 0, v97
    v_mul_f32 v97, 0.15915494, v97
    v_mul_f32 v95, v96, v96
    v_cos_f32 v97, v97
    v_fma_f32 v95, v95, 2.0, -1.0
    v_cvt_pk_bf16_f32 v98, v96, v95
    v_cvt_pk_bf16_f32 v99, v97, 0
    v_cvt_pk_bf16_f32 v106, 0, v97
    s_waitcnt lgkmcnt(1)
    v_dot2_f32_bf16 v112, v104, v99, 0
    v_dot2_f32_bf16 v113, v104, v106, 0
    v_dot2_f32_bf16 v114, v105, v99, 0
    v_dot2_f32_bf16 v115, v105, v106, 0
    s_waitcnt lgkmcnt(0)
    v_dot2_f32_bf16 v112, v100, v98, v112
    v_dot2_f32_bf16 v113, v101, v98, v113
    v_dot2_f32_bf16 v114, v102, v98, v114
    v_dot2_f32_bf16 v115, v103, v98, v115
    s_waitcnt vmcnt(1)
    v_lshlrev_b32 v108, 16, v60
    v_and_b32 v109, s3, v60
    v_lshlrev_b32 v110, 16, v61
    v_and_b32 v111, s3, v61
    s_cmp_lg_u32 s6, 0
    v_mul_f32 v108, v108, v112
    v_mul_f32 v109, v109, v113
    v_mul_f32 v110, v110, v114
    v_mul_f32 v111, v111, v115
    s_cbranch_scc1 P2_FL29
    v_cvt_rpi_i32_f32 v112, v108
    ds_add_u32 v94, v112 offset:0
    v_cvt_rpi_i32_f32 v113, v109
    ds_add_u32 v94, v113 offset:6272
    v_cvt_rpi_i32_f32 v114, v110
    ds_add_u32 v94, v114 offset:12544
    v_cvt_rpi_i32_f32 v115, v111
    ds_add_u32 v94, v115 offset:18816
    s_branch P2_SK29
P2_FL29:
    ds_add_f32 v94, v108 offset:0
    ds_add_f32 v94, v109 offset:6272
    ds_add_f32 v94, v110 offset:12544
    ds_add_f32 v94, v111 offset:18816
P2_SK29:
    s_mov_b64 exec, -1
    s_waitcnt vmcnt(1)
    s_sub_i32 s14, s89, 6144
    s_max_i32 s14, s14, 0
    s_bfm_b64 exec, s14, 0
    s_cmp_ge_i32 s14, 64
    s_cselect_b64 exec, -1, exec
    v_mov_b32 v90, v65
    buffer_load_dwordx2 v[64:65], v64, s[20:23], 0 offen
    s_mov_b64 exec, -1
    s_sub_i32 s14, s89, 5120
    s_max_i32 s14, s14, 0
    s_bfm_b64 exec, s14, 0
    s_cmp_ge_i32 s14, 64
    s_cselect_b64 exec, -1, exec
    s_cbranch_execz P2_SK30
    v_and_b32 v94, 0xffff, v89
    v_add_u32 v93, v94, v94
    v_add_u32 v92, v93, v93
    ds_read_b64 v[104:105], v93 offset:25088
    ds_read_b128 v[100:103], v92 offset:37632
    v_and_b32 v95, s3, v89
    v_mul_f32 v96, 0.15915494, v95
    v_mul_f32 v97, 0x40400000, v95
    v_cos_f32 v96, v96
    v_cvt_pk_bf16_f32 v97, 0, v97
    v_mul_f32 v97, 0.15915494, v97
    v_mul_f32 v95, v96, v96
    v_cos_f32 v97, v97
    v_fma_f32 v95, v95, 2.0, -1.0
    v_cvt_pk_bf16_f32 v98, v96, v95
    v_cvt_pk_bf16_f32 v99, v97, 0
    v_cvt_pk_bf16_f32 v106, 0, v97
    s_waitcnt lgkmcnt(1)
    v_dot2_f32_bf16 v112, v104, v99, 0
    v_dot2_f32_bf16 v113, v104, v106, 0
    v_dot2_f32_bf16 v114, v105, v99, 0
    v_dot2_f32_bf16 v115, v105, v106, 0
    s_waitcnt lgkmcnt(0)
    v_dot2_f32_bf16 v112, v100, v98, v112
    v_dot2_f32_bf16 v113, v101, v98, v113
    v_dot2_f32_bf16 v114, v102, v98, v114
    v_dot2_f32_bf16 v115, v103, v98, v115
    s_waitcnt vmcnt(1)
    v_lshlrev_b32 v108, 16, v62
    v_and_b32 v109, s3, v62
    v_lshlrev_b32 v110, 16, v63
    v_and_b32 v111, s3, v63
    s_cmp_lg_u32 s6, 0
    v_mul_f32 v108, v108, v112
    v_mul_f32 v109, v109, v113
    v_mul_f32 v110, v110, v114
    v_mul_f32 v111, v111, v115
    s_cbranch_scc1 P2_FL30
    v_cvt_rpi_i32_f32 v112, v108
    ds_add_u32 v94, v112 offset:0
    v_cvt_rpi_i32_f32 v113, v109
    ds_add_u32 v94, v113 offset:6272
    v_cvt_rpi_i32_f32 v114, v110
    ds_add_u32 v94, v114 offset:12544
    v_cvt_rpi_i32_f32 v115, v111
    ds_add_u32 v94, v115 offset:18816
    s_branch P2_SK30
P2_FL30:
    ds_add_f32 v94, v108 offset:0
    ds_add_f32 v94, v109 offset:6272
    ds_add_f32 v94, v110 offset:12544
    ds_add_f32 v94, v111 offset:18816
P2_SK30:
    s_mov_b64 exec, -1
    s_waitcnt vmcnt(1)
    s_sub_i32 s14, s89, 7168
    s_max_i32 s14, s14, 0
    s_bfm_b64 exec, s14, 0
    s_cmp_ge_i32 s14, 64
    s_cselect_b64 exec, -1, exec
    v_mov_b32 v91, v67
    buffer_load_dwordx2 v[66:67], v66, s[20:23], 0 offen
    s_mov_b64 exec, -1
    s_sub_i32 s14, s89, 6144
    s_max_i32 s14, s14, 0
    s_bfm_b64 exec, s14, 0
    s_cmp_ge_i32 s14, 64
    s_cselect_b64 exec, -1, exec
    s_cbranch_execz P2_SK31
    v_and_b32 v94, 0xffff, v90
    v_add_u32 v93, v94, v94
    v_add_u32 v92, v93, v93
    ds_read_b64 v[104:105], v93 offset:25088
    ds_read_b128 v[100:103], v92 offset:37632
    v_and_b32 v95, s3, v90
    v_mul_f32 v96, 0.15915494, v95
    v_mul_f32 v97, 0x40400000, v95
    v_cos_f32 v96, v96
    v_cvt_pk_bf16_f32 v97, 0, v97
    v_mul_f32 v97, 0.15915494, v97
    v_mul_f32 v95, v96, v96
    v_cos_f32 v97, v97
    v_fma_f32 v95, v95, 2.0, -1.0
    v_cvt_pk_bf16_f32 v98, v96, v95
    v_cvt_pk_bf16_f32 v99, v97, 0
    v_cvt_pk_bf16_f32 v106, 0, v97
    s_waitcnt lgkmcnt(1)
    v_dot2_f32_bf16 v112, v104, v99, 0
    v_dot2_f32_bf16 v113, v104, v106, 0
    v_dot2_f32_bf16 v114, v105, v99, 0
    v_dot2_f32_bf16 v115, v105, v106, 0
    s_waitcnt lgkmcnt(0)
    v_dot2_f32_bf16 v112, v100, v98, v112
    v_dot2_f32_bf16 v113, v101, v98, v113
    v_dot2_f32_bf16 v114, v102, v98, v114
    v_dot2_f32_bf16 v115, v103, v98, v115
    s_waitcnt vmcnt(1)
    v_lshlrev_b32 v108, 16, v64
    v_and_b32 v109, s3, v64
    v_lshlrev_b32 v110, 16, v65
    v_and_b32 v111, s3, v65
    s_cmp_lg_u32 s6, 0
    v_mul_f32 v108, v108, v112
    v_mul_f32 v109, v109, v113
    v_mul_f32 v110, v110, v114
    v_mul_f32 v111, v111, v115
    s_cbranch_scc1 P2_FL31
    v_cvt_rpi_i32_f32 v112, v108
    ds_add_u32 v94, v112 offset:0
    v_cvt_rpi_i32_f32 v113, v109
    ds_add_u32 v94, v113 offset:6272
    v_cvt_rpi_i32_f32 v114, v110
    ds_add_u32 v94, v114 offset:12544
    v_cvt_rpi_i32_f32 v115, v111
    ds_add_u32 v94, v115 offset:18816
    s_branch P2_SK31
P2_FL31:
    ds_add_f32 v94, v108 offset:0
    ds_add_f32 v94, v109 offset:6272
    ds_add_f32 v94, v110 offset:12544
    ds_add_f32 v94, v111 offset:18816
P2_SK31:
    s_mov_b64 exec, -1
    s_waitcnt vmcnt(1)
    s_sub_i32 s14, s89, 7168
    s_max_i32 s14, s14, 0
    s_bfm_b64 exec, s14, 0
    s_cmp_ge_i32 s14, 64
    s_cselect_b64 exec, -1, exec
    s_cbranch_execz P2_SK32
    v_and_b32 v94, 0xffff, v91
    v_add_u32 v93, v94, v94
    v_add_u32 v92, v93, v93
    ds_read_b64 v[104:105], v93 offset:25088
    ds_read_b128 v[100:103], v92 offset:37632
    v_and_b32 v95, s3, v91
    v_mul_f32 v96, 0.15915494, v95
    v_mul_f32 v97, 0x40400000, v95
    v_cos_f32 v96, v96
    v_cvt_pk_bf16_f32 v97, 0, v97
    v_mul_f32 v97, 0.15915494, v97
    v_mul_f32 v95, v96, v96
    v_cos_f32 v97, v97
    v_fma_f32 v95, v95, 2.0, -1.0
    v_cvt_pk_bf16_f32 v98, v96, v95
    v_cvt_pk_bf16_f32 v99, v97, 0
    v_cvt_pk_bf16_f32 v106, 0, v97
    s_waitcnt lgkmcnt(1)
    v_dot2_f32_bf16 v112, v104, v99, 0
    v_dot2_f32_bf16 v113, v104, v106, 0
    v_dot2_f32_bf16 v114, v105, v99, 0
    v_dot2_f32_bf16 v115, v105, v106, 0
    s_waitcnt lgkmcnt(0)
    v_dot2_f32_bf16 v112, v100, v98, v112
    v_dot2_f32_bf16 v113, v101, v98, v113
    v_dot2_f32_bf16 v114, v102, v98, v114
    v_dot2_f32_bf16 v115, v103, v98, v115
    s_waitcnt vmcnt(0)
    v_lshlrev_b32 v108, 16, v66
    v_and_b32 v109, s3, v66
    v_lshlrev_b32 v110, 16, v67
    v_and_b32 v111, s3, v67
    s_cmp_lg_u32 s6, 0
    v_mul_f32 v108, v108, v112
    v_mul_f32 v109, v109, v113
    v_mul_f32 v110, v110, v114
    v_mul_f32 v111, v111, v115
    s_cbranch_scc1 P2_FL32
    v_cvt_rpi_i32_f32 v112, v108
    ds_add_u32 v94, v112 offset:0
    v_cvt_rpi_i32_f32 v113, v109
    ds_add_u32 v94, v113 offset:6272
    v_cvt_rpi_i32_f32 v114, v110
    ds_add_u32 v94, v114 offset:12544
    v_cvt_rpi_i32_f32 v115, v111
    ds_add_u32 v94, v115 offset:18816
    s_branch P2_SK32
P2_FL32:
    ds_add_f32 v94, v108 offset:0
    ds_add_f32 v94, v109 offset:6272
    ds_add_f32 v94, v110 offset:12544
    ds_add_f32 v94, v111 offset:18816
P2_SK32:
    s_mov_b64 exec, -1
    s_waitcnt vmcnt(0)
    s_waitcnt vmcnt(0)
    s_add_u32 s76, s76, 384
P2_LOOP0:
    s_sub_i32 s84, s72, s76
    s_cmp_le_i32 s84, 0
    s_cbranch_scc1 P2_LOOP_END0
    ds_write_b64 v2, v[18:19] offset:0
    ds_write_b64 v2, v[18:19] offset:512
    s_add_u32 s15, s76, 0
    v_subrev_u32 v12, s15, v4
    v_cmp_gt_u32 vcc, 256, v12
    v_lshl_add_u32 v12, v12, 2, s7
    s_mov_b64 exec, vcc
    ds_write_b32 v12, v8
    s_mov_b64 exec, -1
    ds_read_b32 v20, v1 offset:0
    ds_read_b32 v22, v1 offset:256
    ds_read_b32 v24, v1 offset:512
    ds_read_b32 v26, v1 offset:768
    s_lshl_b32 s15, s15, 3
    s_waitcnt lgkmcnt(0)
    v_max_u32_dpp v20, v20, v20 row_shr:1 row_mask:0xf bank_mask:0xf bound_ctrl:0
    v_max_u32_dpp v22, v22, v22 row_shr:1 row_mask:0xf bank_mask:0xf bound_ctrl:0
    v_max_u32_dpp v24, v24, v24 row_shr:1 row_mask:0xf bank_mask:0xf bound_ctrl:0
    v_max_u32_dpp v26, v26, v26 row_shr:1 row_mask:0xf bank_mask:0xf bound_ctrl:0
    v_max_u32_dpp v20, v20, v20 row_shr:2 row_mask:0xf bank_mask:0xf bound_ctrl:0
    v_max_u32_dpp v22, v22, v22 row_shr:2 row_mask:0xf bank_mask:0xf bound_ctrl:0
    v_max_u32_dpp v24, v24, v24 row_shr:2 row_mask:0xf bank_mask:0xf bound_ctrl:0
    v_max_u32_dpp v26, v26, v26 row_shr:2 row_mask:0xf bank_mask:0xf bound_ctrl:0
    v_max_u32_dpp v20, v20, v20 row_shr:4 row_mask:0xf bank_mask:0xf bound_ctrl:0
    v_max_u32_dpp v22, v22, v22 row_shr:4 row_mask:0xf bank_mask:0xf bound_ctrl:0
    v_max_u32_dpp v24, v24, v24 row_shr:4 row_mask:0xf bank_mask:0xf bound_ctrl:0
    v_max_u32_dpp v26, v26, v26 row_shr:4 row_mask:0xf bank_mask:0xf bound_ctrl:0
    v_max_u32_dpp v20, v20, v20 row_shr:8 row_mask:0xf bank_mask:0xf bound_ctrl:0
    v_max_u32_dpp v22, v22, v22 row_shr:8 row_mask:0xf bank_mask:0xf bound_ctrl:0
    v_max_u32_dpp v24, v24, v24 row_shr:8 row_mask:0xf bank_mask:0xf bound_ctrl:0
    v_max_u32_dpp v26, v26, v26 row_shr:8 row_mask:0xf bank_mask:0xf bound_ctrl:0
    v_max_u32_dpp v20, v20, v20 row_bcast:15 row_mask:0xa bank_mask:0xf
    v_max_u32_dpp v22, v22, v22 row_bcast:15 row_mask:0xa bank_mask:0xf
    v_max_u32_dpp v24, v24, v24 row_bcast:15 row_mask:0xa bank_mask:0xf
    v_max_u32_dpp v26, v26, v26 row_bcast:15 row_mask:0xa bank_mask:0xf
    v_max_u32_dpp v20, v20, v20 row_bcast:31 row_mask:0xc bank_mask:0xf
    v_max_u32_dpp v22, v22, v22 row_bcast:31 row_mask:0xc bank_mask:0xf
    v_max_u32_dpp v24, v24, v24 row_bcast:31 row_mask:0xc bank_mask:0xf
    v_max_u32_dpp v26, v26, v26 row_bcast:31 row_mask:0xc bank_mask:0xf
    v_max_u32 v20, s80, v20
    s_nop 0
    v_readlane_b32 s80, v20, 63
    v_add3_u32 v20, v20, v3, s15
    s_add_u32 s15, s15, 512
    s_max_i32 s14, s84, 0
    s_bfm_b64 exec, s14, 0
    s_cmp_ge_i32 s14, 64
    s_cselect_b64 exec, -1, exec
    buffer_load_dwordx2 v[20:21], v20, s[16:19], 0 offen
    s_mov_b64 exec, -1
    v_max_u32 v22, s80, v22
    s_nop 0
    v_readlane_b32 s80, v22, 63
    v_add3_u32 v22, v22, v3, s15
    s_add_u32 s15, s15, 512
    s_sub_i32 s14, s84, 64
    s_max_i32 s14, s14, 0
    s_bfm_b64 exec, s14, 0
    s_cmp_ge_i32 s14, 64
    s_cselect_b64 exec, -1, exec
    buffer_load_dwordx2 v[22:23], v22, s[16:19], 0 offen
    s_mov_b64 exec, -1
    v_max_u32 v24, s80, v24
    s_nop 0
    v_readlane_b32 s80, v24, 63
    v_add3_u32 v24, v24, v3, s15
    s_add_u32 s15, s15, 512
    s_sub_i32 s14, s84, 128
    s_max_i32 s14, s14, 0
    s_bfm_b64 exec, s14, 0
    s_cmp_ge_i32 s14, 64
    s_cselect_b64 exec, -1, exec
    buffer_load_dwordx2 v[24:25], v24, s[16:19], 0 offen
    s_mov_b64 exec, -1
    v_max_u32 v26, s80, v26
    s_nop 0
    v_readlane_b32 s80, v26, 63
    v_add3_u32 v26, v26, v3, s15
    s_add_u32 s15, s15, 512
    s_sub_i32 s14, s84, 192
    s_max_i32 s14, s14, 0
    s_bfm_b64 exec, s14, 0
    s_cmp_ge_i32 s14, 64
    s_cselect_b64 exec, -1, exec
    buffer_load_dwordx2 v[26:27], v26, s[16:19], 0 offen
    s_mov_b64 exec, -1
    s_waitcnt vmcnt(3)
    s_max_i32 s14, s84, 0
    s_bfm_b64 exec, s14, 0
    s_cmp_ge_i32 s14, 64
    s_cselect_b64 exec, -1, exec
    v_mov_b32 v68, v21
    buffer_load_dwordx2 v[20:21], v20, s[20:23], 0 offen
    s_mov_b64 exec, -1
    s_waitcnt vmcnt(3)
    s_sub_i32 s14, s84, 64
    s_max_i32 s14, s14, 0
    s_bfm_b64 exec, s14, 0
    s_cmp_ge_i32 s14, 64
    s_cselect_b64 exec, -1, exec
    v_mov_b32 v69, v23
    buffer_load_dwordx2 v[22:23], v22, s[20:23], 0 offen
    s_mov_b64 exec, -1
    s_waitcnt vmcnt(3)
    s_sub_i32 s14, s84, 128
    s_max_i32 s14, s14, 0
    s_bfm_b64 exec, s14, 0
    s_cmp_ge_i32 s14, 64
    s_cselect_b64 exec, -1, exec
    v_mov_b32 v70, v25
    buffer_load_dwordx2 v[24:25], v24, s[20:23], 0 offen
    s_mov_b64 exec, -1
    s_waitcnt vmcnt(3)
    s_sub_i32 s14, s84, 192
    s_max_i32 s14, s14, 0
    s_bfm_b64 exec, s14, 0
    s_cmp_ge_i32 s14, 64
    s_cselect_b64 exec, -1, exec
    v_mov_b32 v71, v27
    buffer_load_dwordx2 v[26:27], v26, s[20:23], 0 offen
    s_mov_b64 exec, -1
    s_max_i32 s14, s84, 0
    s_bfm_b64 exec, s14, 0
    s_cmp_ge_i32 s14, 64
    s_cselect_b64 exec, -1, exec
    s_cbranch_execz P2_SK33
    v_and_b32 v94, 0xffff, v68
    v_add_u32 v93, v94, v94
    v_add_u32 v92, v93, v93
    ds_read_b64 v[104:105], v93 offset:25088
    ds_read_b128 v[100:103], v92 offset:37632
    v_and_b32 v95, s3, v68
    v_mul_f32 v96, 0.15915494, v95
    v_mul_f32 v97, 0x40400000, v95
    v_cos_f32 v96, v96
    v_cvt_pk_bf16_f32 v97, 0, v97
    v_mul_f32 v97, 0.15915494, v97
    v_mul_f32 v95, v96, v96
    v_cos_f32 v97, v97
    v_fma_f32 v95, v95, 2.0, -1.0
    v_cvt_pk_bf16_f32 v98, v96, v95
    v_cvt_pk_bf16_f32 v99, v97, 0
    v_cvt_pk_bf16_f32 v106, 0, v97
    s_waitcnt lgkmcnt(1)
    v_dot2_f32_bf16 v112, v104, v99, 0
    v_dot2_f32_bf16 v113, v104, v106, 0
    v_dot2_f32_bf16 v114, v105, v99, 0
    v_dot2_f32_bf16 v115, v105, v106, 0
    s_waitcnt lgkmcnt(0)
    v_dot2_f32_bf16 v112, v100, v98, v112
    v_dot2_f32_bf16 v113, v101, v98, v113
    v_dot2_f32_bf16 v114, v102, v98, v114
    v_dot2_f32_bf16 v115, v103, v98, v115
    s_waitcnt vmcnt(3)
    v_lshlrev_b32 v108, 16, v20
    v_and_b32 v109, s3, v20
    v_lshlrev_b32 v110, 16, v21
    v_and_b32 v111, s3, v21
    s_cmp_lg_u32 s6, 0
    v_mul_f32 v108, v108, v112
    v_mul_f32 v109, v109, v113
    v_mul_f32 v110, v110, v114
    v_mul_f32 v111, v111, v115
    s_cbranch_scc1 P2_FL33
    v_cvt_rpi_i32_f32 v112, v108
    ds_add_u32 v94, v112 offset:0
    v_cvt_rpi_i32_f32 v113, v109
    ds_add_u32 v94, v113 offset:6272
    v_cvt_rpi_i32_f32 v114, v110
    ds_add_u32 v94, v114 offset:12544
    v_cvt_rpi_i32_f32 v115, v111
    ds_add_u32 v94, v115 offset:18816
    s_branch P2_SK33
P2_FL33:
    ds_add_f32 v94, v108 offset:0
    ds_add_f32 v94, v109 offset:6272
    ds_add_f32 v94, v110 offset:12544
    ds_add_f32 v94, v111 offset:18816
P2_SK33:
    s_mov_b64 exec, -1
    s_waitcnt vmcnt(3)
    s_sub_i32 s14, s84, 64
    s_max_i32 s14, s14, 0
    s_bfm_b64 exec, s14, 0
    s_cmp_ge_i32 s14, 64
    s_cselect_b64 exec, -1, exec
    s_cbranch_execz P2_SK34
    v_and_b32 v94, 0xffff, v69
    v_add_u32 v93, v94, v94
    v_add_u32 v92, v93, v93
    ds_read_b64 v[104:105], v93 offset:25088
    ds_read_b128 v[100:103], v92 offset:37632
    v_and_b32 v95, s3, v69
    v_mul_f32 v96, 0.15915494, v95
    v_mul_f32 v97, 0x40400000, v95
    v_cos_f32 v96, v96
    v_cvt_pk_bf16_f32 v97, 0, v97
    v_mul_f32 v97, 0.15915494, v97
    v_mul_f32 v95, v96, v96
    v_cos_f32 v97, v97
    v_fma_f32 v95, v95, 2.0, -1.0
    v_cvt_pk_bf16_f32 v98, v96, v95
    v_cvt_pk_bf16_f32 v99, v97, 0
    v_cvt_pk_bf16_f32 v106, 0, v97
    s_waitcnt lgkmcnt(1)
    v_dot2_f32_bf16 v112, v104, v99, 0
    v_dot2_f32_bf16 v113, v104, v106, 0
    v_dot2_f32_bf16 v114, v105, v99, 0
    v_dot2_f32_bf16 v115, v105, v106, 0
    s_waitcnt lgkmcnt(0)
    v_dot2_f32_bf16 v112, v100, v98, v112
    v_dot2_f32_bf16 v113, v101, v98, v113
    v_dot2_f32_bf16 v114, v102, v98, v114
    v_dot2_f32_bf16 v115, v103, v98, v115
    s_waitcnt vmcnt(2)
    v_lshlrev_b32 v108, 16, v22
    v_and_b32 v109, s3, v22
    v_lshlrev_b32 v110, 16, v23
    v_and_b32 v111, s3, v23
    s_cmp_lg_u32 s6, 0
    v_mul_f32 v108, v108, v112
    v_mul_f32 v109, v109, v113
    v_mul_f32 v110, v110, v114
    v_mul_f32 v111, v111, v115
    s_cbranch_scc1 P2_FL34
    v_cvt_rpi_i32_f32 v112, v108
    ds_add_u32 v94, v112 offset:0
    v_cvt_rpi_i32_f32 v113, v109
    ds_add_u32 v94, v113 offset:6272
    v_cvt_rpi_i32_f32 v114, v110
    ds_add_u32 v94, v114 offset:12544
    v_cvt_rpi_i32_f32 v115, v111
    ds_add_u32 v94, v115 offset:18816
    s_branch P2_SK34
P2_FL34:
    ds_add_f32 v94, v108 offset:0
    ds_add_f32 v94, v109 offset:6272
    ds_add_f32 v94, v110 offset:12544
    ds_add_f32 v94, v111 offset:18816
P2_SK34:
    s_mov_b64 exec, -1
    s_waitcnt vmcnt(2)
    s_sub_i32 s14, s84, 128
    s_max_i32 s14, s14, 0
    s_bfm_b64 exec, s14, 0
    s_cmp_ge_i32 s14, 64
    s_cselect_b64 exec, -1, exec
    s_cbranch_execz P2_SK35
    v_and_b32 v94, 0xffff, v70
    v_add_u32 v93, v94, v94
    v_add_u32 v92, v93, v93
    ds_read_b64 v[104:105], v93 offset:25088
    ds_read_b128 v[100:103], v92 offset:37632
    v_and_b32 v95, s3, v70
    v_mul_f32 v96, 0.15915494, v95
    v_mul_f32 v97, 0x40400000, v95
    v_cos_f32 v96, v96
    v_cvt_pk_bf16_f32 v97, 0, v97
    v_mul_f32 v97, 0.15915494, v97
    v_mul_f32 v95, v96, v96
    v_cos_f32 v97, v97
    v_fma_f32 v95, v95, 2.0, -1.0
    v_cvt_pk_bf16_f32 v98, v96, v95
    v_cvt_pk_bf16_f32 v99, v97, 0
    v_cvt_pk_bf16_f32 v106, 0, v97
    s_waitcnt lgkmcnt(1)
    v_dot2_f32_bf16 v112, v104, v99, 0
    v_dot2_f32_bf16 v113, v104, v106, 0
    v_dot2_f32_bf16 v114, v105, v99, 0
    v_dot2_f32_bf16 v115, v105, v106, 0
    s_waitcnt lgkmcnt(0)
    v_dot2_f32_bf16 v112, v100, v98, v112
    v_dot2_f32_bf16 v113, v101, v98, v113
    v_dot2_f32_bf16 v114, v102, v98, v114
    v_dot2_f32_bf16 v115, v103, v98, v115
    s_waitcnt vmcnt(1)
    v_lshlrev_b32 v108, 16, v24
    v_and_b32 v109, s3, v24
    v_lshlrev_b32 v110, 16, v25
    v_and_b32 v111, s3, v25
    s_cmp_lg_u32 s6, 0
    v_mul_f32 v108, v108, v112
    v_mul_f32 v109, v109, v113
    v_mul_f32 v110, v110, v114
    v_mul_f32 v111, v111, v115
    s_cbranch_scc1 P2_FL35
    v_cvt_rpi_i32_f32 v112, v108
    ds_add_u32 v94, v112 offset:0
    v_cvt_rpi_i32_f32 v113, v109
    ds_add_u32 v94, v113 offset:6272
    v_cvt_rpi_i32_f32 v114, v110
    ds_add_u32 v94, v114 offset:12544
    v_cvt_rpi_i32_f32 v115, v111
    ds_add_u32 v94, v115 offset:18816
    s_branch P2_SK35
P2_FL35:
    ds_add_f32 v94, v108 offset:0
    ds_add_f32 v94, v109 offset:6272
    ds_add_f32 v94, v110 offset:12544
    ds_add_f32 v94, v111 offset:18816
P2_SK35:
    s_mov_b64 exec, -1
    s_waitcnt vmcnt(1)
    s_sub_i32 s14, s84, 192
    s_max_i32 s14, s14, 0
    s_bfm_b64 exec, s14, 0
    s_cmp_ge_i32 s14, 64
    s_cselect_b64 exec, -1, exec
    s_cbranch_execz P2_SK36
    v_and_b32 v94, 0xffff, v71
    v_add_u32 v93, v94, v94
    v_add_u32 v92, v93, v93
    ds_read_b64 v[104:105], v93 offset:25088
    ds_read_b128 v[100:103], v92 offset:37632
    v_and_b32 v95, s3, v71
    v_mul_f32 v96, 0.15915494, v95
    v_mul_f32 v97, 0x40400000, v95
    v_cos_f32 v96, v96
    v_cvt_pk_bf16_f32 v97, 0, v97
    v_mul_f32 v97, 0.15915494, v97
    v_mul_f32 v95, v96, v96
    v_cos_f32 v97, v97
    v_fma_f32 v95, v95, 2.0, -1.0
    v_cvt_pk_bf16_f32 v98, v96, v95
    v_cvt_pk_bf16_f32 v99, v97, 0
    v_cvt_pk_bf16_f32 v106, 0, v97
    s_waitcnt lgkmcnt(1)
    v_dot2_f32_bf16 v112, v104, v99, 0
    v_dot2_f32_bf16 v113, v104, v106, 0
    v_dot2_f32_bf16 v114, v105, v99, 0
    v_dot2_f32_bf16 v115, v105, v106, 0
    s_waitcnt lgkmcnt(0)
    v_dot2_f32_bf16 v112, v100, v98, v112
    v_dot2_f32_bf16 v113, v101, v98, v113
    v_dot2_f32_bf16 v114, v102, v98, v114
    v_dot2_f32_bf16 v115, v103, v98, v115
    s_waitcnt vmcnt(0)
    v_lshlrev_b32 v108, 16, v26
    v_and_b32 v109, s3, v26
    v_lshlrev_b32 v110, 16, v27
    v_and_b32 v111, s3, v27
    s_cmp_lg_u32 s6, 0
    v_mul_f32 v108, v108, v112
    v_mul_f32 v109, v109, v113
    v_mul_f32 v110, v110, v114
    v_mul_f32 v111, v111, v115
    s_cbranch_scc1 P2_FL36
    v_cvt_rpi_i32_f32 v112, v108
    ds_add_u32 v94, v112 offset:0
    v_cvt_rpi_i32_f32 v113, v109
    ds_add_u32 v94, v113 offset:6272
    v_cvt_rpi_i32_f32 v114, v110
    ds_add_u32 v94, v114 offset:12544
    v_cvt_rpi_i32_f32 v115, v111
    ds_add_u32 v94, v115 offset:18816
    s_branch P2_SK36
P2_FL36:
    ds_add_f32 v94, v108 offset:0
    ds_add_f32 v94, v109 offset:6272
    ds_add_f32 v94, v110 offset:12544
    ds_add_f32 v94, v111 offset:18816
P2_SK36:
    s_mov_b64 exec, -1
    s_waitcnt vmcnt(0)
    s_waitcnt vmcnt(0)
    s_add_u32 s76, s76, 256
    s_branch P2_LOOP0
P2_LOOP_END0:
    s_add_u32 s77, s77, 512
P2_LOOP1:
    s_sub_i32 s85, s73, s77
    s_cmp_le_i32 s85, 0
    s_cbranch_scc1 P2_LOOP_END1
    ds_write_b64 v2, v[18:19] offset:0
    ds_write_b64 v2, v[18:19] offset:512
    s_add_u32 s15, s77, 0
    v_subrev_u32 v12, s15, v5
    v_cmp_gt_u32 vcc, 256, v12
    v_lshl_add_u32 v12, v12, 2, s7
    s_mov_b64 exec, vcc
    ds_write_b32 v12, v9
    s_mov_b64 exec, -1
    ds_read_b32 v20, v1 offset:0
    ds_read_b32 v22, v1 offset:256
    ds_read_b32 v24, v1 offset:512
    ds_read_b32 v26, v1 offset:768
    s_lshl_b32 s15, s15, 3
    s_waitcnt lgkmcnt(0)
    v_max_u32_dpp v20, v20, v20 row_shr:1 row_mask:0xf bank_mask:0xf bound_ctrl:0
    v_max_u32_dpp v22, v22, v22 row_shr:1 row_mask:0xf bank_mask:0xf bound_ctrl:0
    v_max_u32_dpp v24, v24, v24 row_shr:1 row_mask:0xf bank_mask:0xf bound_ctrl:0
    v_max_u32_dpp v26, v26, v26 row_shr:1 row_mask:0xf bank_mask:0xf bound_ctrl:0
    v_max_u32_dpp v20, v20, v20 row_shr:2 row_mask:0xf bank_mask:0xf bound_ctrl:0
    v_max_u32_dpp v22, v22, v22 row_shr:2 row_mask:0xf bank_mask:0xf bound_ctrl:0
    v_max_u32_dpp v24, v24, v24 row_shr:2 row_mask:0xf bank_mask:0xf bound_ctrl:0
    v_max_u32_dpp v26, v26, v26 row_shr:2 row_mask:0xf bank_mask:0xf bound_ctrl:0
    v_max_u32_dpp v20, v20, v20 row_shr:4 row_mask:0xf bank_mask:0xf bound_ctrl:0
    v_max_u32_dpp v22, v22, v22 row_shr:4 row_mask:0xf bank_mask:0xf bound_ctrl:0
    v_max_u32_dpp v24, v24, v24 row_shr:4 row_mask:0xf bank_mask:0xf bound_ctrl:0
    v_max_u32_dpp v26, v26, v26 row_shr:4 row_mask:0xf bank_mask:0xf bound_ctrl:0
    v_max_u32_dpp v20, v20, v20 row_shr:8 row_mask:0xf bank_mask:0xf bound_ctrl:0
    v_max_u32_dpp v22, v22, v22 row_shr:8 row_mask:0xf bank_mask:0xf bound_ctrl:0
    v_max_u32_dpp v24, v24, v24 row_shr:8 row_mask:0xf bank_mask:0xf bound_ctrl:0
    v_max_u32_dpp v26, v26, v26 row_shr:8 row_mask:0xf bank_mask:0xf bound_ctrl:0
    v_max_u32_dpp v20, v20, v20 row_bcast:15 row_mask:0xa bank_mask:0xf
    v_max_u32_dpp v22, v22, v22 row_bcast:15 row_mask:0xa bank_mask:0xf
    v_max_u32_dpp v24, v24, v24 row_bcast:15 row_mask:0xa bank_mask:0xf
    v_max_u32_dpp v26, v26, v26 row_bcast:15 row_mask:0xa bank_mask:0xf
    v_max_u32_dpp v20, v20, v20 row_bcast:31 row_mask:0xc bank_mask:0xf
    v_max_u32_dpp v22, v22, v22 row_bcast:31 row_mask:0xc bank_mask:0xf
    v_max_u32_dpp v24, v24, v24 row_bcast:31 row_mask:0xc bank_mask:0xf
    v_max_u32_dpp v26, v26, v26 row_bcast:31 row_mask:0xc bank_mask:0xf
    v_max_u32 v20, s81, v20
    s_nop 0
    v_readlane_b32 s81, v20, 63
    v_add3_u32 v20, v20, v3, s15
    s_add_u32 s15, s15, 512
    s_max_i32 s14, s85, 0
    s_bfm_b64 exec, s14, 0
    s_cmp_ge_i32 s14, 64
    s_cselect_b64 exec, -1, exec
    buffer_load_dwordx2 v[20:21], v20, s[16:19], 0 offen
    s_mov_b64 exec, -1
    v_max_u32 v22, s81, v22
    s_nop 0
    v_readlane_b32 s81, v22, 63
    v_add3_u32 v22, v22, v3, s15
    s_add_u32 s15, s15, 512
    s_sub_i32 s14, s85, 64
    s_max_i32 s14, s14, 0
    s_bfm_b64 exec, s14, 0
    s_cmp_ge_i32 s14, 64
    s_cselect_b64 exec, -1, exec
    buffer_load_dwordx2 v[22:23], v22, s[16:19], 0 offen
    s_mov_b64 exec, -1
    v_max_u32 v24, s81, v24
    s_nop 0
    v_readlane_b32 s81, v24, 63
    v_add3_u32 v24, v24, v3, s15
    s_add_u32 s15, s15, 512
    s_sub_i32 s14, s85, 128
    s_max_i32 s14, s14, 0
    s_bfm_b64 exec, s14, 0
    s_cmp_ge_i32 s14, 64
    s_cselect_b64 exec, -1, exec
    buffer_load_dwordx2 v[24:25], v24, s[16:19], 0 offen
    s_mov_b64 exec, -1
    v_max_u32 v26, s81, v26
    s_nop 0
    v_readlane_b32 s81, v26, 63
    v_add3_u32 v26, v26, v3, s15
    s_add_u32 s15, s15, 512
    s_sub_i32 s14, s85, 192
    s_max_i32 s14, s14, 0
    s_bfm_b64 exec, s14, 0
    s_cmp_ge_i32 s14, 64
    s_cselect_b64 exec, -1, exec
    buffer_load_dwordx2 v[26:27], v26, s[16:19], 0 offen
    s_mov_b64 exec, -1
    s_waitcnt vmcnt(3)
    s_max_i32 s14, s85, 0
    s_bfm_b64 exec, s14, 0
    s_cmp_ge_i32 s14, 64
    s_cselect_b64 exec, -1, exec
    v_mov_b32 v68, v21
    buffer_load_dwordx2 v[20:21], v20, s[20:23], 0 offen
    s_mov_b64 exec, -1
    s_waitcnt vmcnt(3)
    s_sub_i32 s14, s85, 64
    s_max_i32 s14, s14, 0
    s_bfm_b64 exec, s14, 0
    s_cmp_ge_i32 s14, 64
    s_cselect_b64 exec, -1, exec
    v_mov_b32 v69, v23
    buffer_load_dwordx2 v[22:23], v22, s[20:23], 0 offen
    s_mov_b64 exec, -1
    s_waitcnt vmcnt(3)
    s_sub_i32 s14, s85, 128
    s_max_i32 s14, s14, 0
    s_bfm_b64 exec, s14, 0
    s_cmp_ge_i32 s14, 64
    s_cselect_b64 exec, -1, exec
    v_mov_b32 v70, v25
    buffer_load_dwordx2 v[24:25], v24, s[20:23], 0 offen
    s_mov_b64 exec, -1
    s_waitcnt vmcnt(3)
    s_sub_i32 s14, s85, 192
    s_max_i32 s14, s14, 0
    s_bfm_b64 exec, s14, 0
    s_cmp_ge_i32 s14, 64
    s_cselect_b64 exec, -1, exec
    v_mov_b32 v71, v27
    buffer_load_dwordx2 v[26:27], v26, s[20:23], 0 offen
    s_mov_b64 exec, -1
    s_max_i32 s14, s85, 0
    s_bfm_b64 exec, s14, 0
    s_cmp_ge_i32 s14, 64
    s_cselect_b64 exec, -1, exec
    s_cbranch_execz P2_SK37
    v_and_b32 v94, 0xffff, v68
    v_add_u32 v93, v94, v94
    v_add_u32 v92, v93, v93
    ds_read_b64 v[104:105], v93 offset:25088
    ds_read_b128 v[100:103], v92 offset:37632
    v_and_b32 v95, s3, v68
    v_mul_f32 v96, 0.15915494, v95
    v_mul_f32 v97, 0x40400000, v95
    v_cos_f32 v96, v96
    v_cvt_pk_bf16_f32 v97, 0, v97
    v_mul_f32 v97, 0.15915494, v97
    v_mul_f32 v95, v96, v96
    v_cos_f32 v97, v97
    v_fma_f32 v95, v95, 2.0, -1.0
    v_cvt_pk_bf16_f32 v98, v96, v95
    v_cvt_pk_bf16_f32 v99, v97, 0
    v_cvt_pk_bf16_f32 v106, 0, v97
    s_waitcnt lgkmcnt(1)
    v_dot2_f32_bf16 v112, v104, v99, 0
    v_dot2_f32_bf16 v113, v104, v106, 0
    v_dot2_f32_bf16 v114, v105, v99, 0
    v_dot2_f32_bf16 v115, v105, v106, 0
    s_waitcnt lgkmcnt(0)
    v_dot2_f32_bf16 v112, v100, v98, v112
    v_dot2_f32_bf16 v113, v101, v98, v113
    v_dot2_f32_bf16 v114, v102, v98, v114
    v_dot2_f32_bf16 v115, v103, v98, v115
    s_waitcnt vmcnt(3)
    v_lshlrev_b32 v108, 16, v20
    v_and_b32 v109, s3, v20
    v_lshlrev_b32 v110, 16, v21
    v_and_b32 v111, s3, v21
    s_cmp_lg_u32 s6, 0
    v_mul_f32 v108, v108, v112
    v_mul_f32 v109, v109, v113
    v_mul_f32 v110, v110, v114
    v_mul_f32 v111, v111, v115
    s_cbranch_scc1 P2_FL37
    v_cvt_rpi_i32_f32 v112, v108
    ds_add_u32 v94, v112 offset:0
    v_cvt_rpi_i32_f32 v113, v109
    ds_add_u32 v94, v113 offset:6272
    v_cvt_rpi_i32_f32 v114, v110
    ds_add_u32 v94, v114 offset:12544
    v_cvt_rpi_i32_f32 v115, v111
    ds_add_u32 v94, v115 offset:18816
    s_branch P2_SK37
P2_FL37:
    ds_add_f32 v94, v108 offset:0
    ds_add_f32 v94, v109 offset:6272
    ds_add_f32 v94, v110 offset:12544
    ds_add_f32 v94, v111 offset:18816
P2_SK37:
    s_mov_b64 exec, -1
    s_waitcnt vmcnt(3)
    s_sub_i32 s14, s85, 64
    s_max_i32 s14, s14, 0
    s_bfm_b64 exec, s14, 0
    s_cmp_ge_i32 s14, 64
    s_cselect_b64 exec, -1, exec
    s_cbranch_execz P2_SK38
    v_and_b32 v94, 0xffff, v69
    v_add_u32 v93, v94, v94
    v_add_u32 v92, v93, v93
    ds_read_b64 v[104:105], v93 offset:25088
    ds_read_b128 v[100:103], v92 offset:37632
    v_and_b32 v95, s3, v69
    v_mul_f32 v96, 0.15915494, v95
    v_mul_f32 v97, 0x40400000, v95
    v_cos_f32 v96, v96
    v_cvt_pk_bf16_f32 v97, 0, v97
    v_mul_f32 v97, 0.15915494, v97
    v_mul_f32 v95, v96, v96
    v_cos_f32 v97, v97
    v_fma_f32 v95, v95, 2.0, -1.0
    v_cvt_pk_bf16_f32 v98, v96, v95
    v_cvt_pk_bf16_f32 v99, v97, 0
    v_cvt_pk_bf16_f32 v106, 0, v97
    s_waitcnt lgkmcnt(1)
    v_dot2_f32_bf16 v112, v104, v99, 0
    v_dot2_f32_bf16 v113, v104, v106, 0
    v_dot2_f32_bf16 v114, v105, v99, 0
    v_dot2_f32_bf16 v115, v105, v106, 0
    s_waitcnt lgkmcnt(0)
    v_dot2_f32_bf16 v112, v100, v98, v112
    v_dot2_f32_bf16 v113, v101, v98, v113
    v_dot2_f32_bf16 v114, v102, v98, v114
    v_dot2_f32_bf16 v115, v103, v98, v115
    s_waitcnt vmcnt(2)
    v_lshlrev_b32 v108, 16, v22
    v_and_b32 v109, s3, v22
    v_lshlrev_b32 v110, 16, v23
    v_and_b32 v111, s3, v23
    s_cmp_lg_u32 s6, 0
    v_mul_f32 v108, v108, v112
    v_mul_f32 v109, v109, v113
    v_mul_f32 v110, v110, v114
    v_mul_f32 v111, v111, v115
    s_cbranch_scc1 P2_FL38
    v_cvt_rpi_i32_f32 v112, v108
    ds_add_u32 v94, v112 offset:0
    v_cvt_rpi_i32_f32 v113, v109
    ds_add_u32 v94, v113 offset:6272
    v_cvt_rpi_i32_f32 v114, v110
    ds_add_u32 v94, v114 offset:12544
    v_cvt_rpi_i32_f32 v115, v111
    ds_add_u32 v94, v115 offset:18816
    s_branch P2_SK38
P2_FL38:
    ds_add_f32 v94, v108 offset:0
    ds_add_f32 v94, v109 offset:6272
    ds_add_f32 v94, v110 offset:12544
    ds_add_f32 v94, v111 offset:18816
P2_SK38:
    s_mov_b64 exec, -1
    s_waitcnt vmcnt(2)
    s_sub_i32 s14, s85, 128
    s_max_i32 s14, s14, 0
    s_bfm_b64 exec, s14, 0
    s_cmp_ge_i32 s14, 64
    s_cselect_b64 exec, -1, exec
    s_cbranch_execz P2_SK39
    v_and_b32 v94, 0xffff, v70
    v_add_u32 v93, v94, v94
    v_add_u32 v92, v93, v93
    ds_read_b64 v[104:105], v93 offset:25088
    ds_read_b128 v[100:103], v92 offset:37632
    v_and_b32 v95, s3, v70
    v_mul_f32 v96, 0.15915494, v95
    v_mul_f32 v97, 0x40400000, v95
    v_cos_f32 v96, v96
    v_cvt_pk_bf16_f32 v97, 0, v97
    v_mul_f32 v97, 0.15915494, v97
    v_mul_f32 v95, v96, v96
    v_cos_f32 v97, v97
    v_fma_f32 v95, v95, 2.0, -1.0
    v_cvt_pk_bf16_f32 v98, v96, v95
    v_cvt_pk_bf16_f32 v99, v97, 0
    v_cvt_pk_bf16_f32 v106, 0, v97
    s_waitcnt lgkmcnt(1)
    v_dot2_f32_bf16 v112, v104, v99, 0
    v_dot2_f32_bf16 v113, v104, v106, 0
    v_dot2_f32_bf16 v114, v105, v99, 0
    v_dot2_f32_bf16 v115, v105, v106, 0
    s_waitcnt lgkmcnt(0)
    v_dot2_f32_bf16 v112, v100, v98, v112
    v_dot2_f32_bf16 v113, v101, v98, v113
    v_dot2_f32_bf16 v114, v102, v98, v114
    v_dot2_f32_bf16 v115, v103, v98, v115
    s_waitcnt vmcnt(1)
    v_lshlrev_b32 v108, 16, v24
    v_and_b32 v109, s3, v24
    v_lshlrev_b32 v110, 16, v25
    v_and_b32 v111, s3, v25
    s_cmp_lg_u32 s6, 0
    v_mul_f32 v108, v108, v112
    v_mul_f32 v109, v109, v113
    v_mul_f32 v110, v110, v114
    v_mul_f32 v111, v111, v115
    s_cbranch_scc1 P2_FL39
    v_cvt_rpi_i32_f32 v112, v108
    ds_add_u32 v94, v112 offset:0
    v_cvt_rpi_i32_f32 v113, v109
    ds_add_u32 v94, v113 offset:6272
    v_cvt_rpi_i32_f32 v114, v110
    ds_add_u32 v94, v114 offset:12544
    v_cvt_rpi_i32_f32 v115, v111
    ds_add_u32 v94, v115 offset:18816
    s_branch P2_SK39
P2_FL39:
    ds_add_f32 v94, v108 offset:0
    ds_add_f32 v94, v109 offset:6272
    ds_add_f32 v94, v110 offset:12544
    ds_add_f32 v94, v111 offset:18816
P2_SK39:
    s_mov_b64 exec, -1
    s_waitcnt vmcnt(1)
    s_sub_i32 s14, s85, 192
    s_max_i32 s14, s14, 0
    s_bfm_b64 exec, s14, 0
    s_cmp_ge_i32 s14, 64
    s_cselect_b64 exec, -1, exec
    s_cbranch_execz P2_SK40
    v_and_b32 v94, 0xffff, v71
    v_add_u32 v93, v94, v94
    v_add_u32 v92, v93, v93
    ds_read_b64 v[104:105], v93 offset:25088
    ds_read_b128 v[100:103], v92 offset:37632
    v_and_b32 v95, s3, v71
    v_mul_f32 v96, 0.15915494, v95
    v_mul_f32 v97, 0x40400000, v95
    v_cos_f32 v96, v96
    v_cvt_pk_bf16_f32 v97, 0, v97
    v_mul_f32 v97, 0.15915494, v97
    v_mul_f32 v95, v96, v96
    v_cos_f32 v97, v97
    v_fma_f32 v95, v95, 2.0, -1.0
    v_cvt_pk_bf16_f32 v98, v96, v95
    v_cvt_pk_bf16_f32 v99, v97, 0
    v_cvt_pk_bf16_f32 v106, 0, v97
    s_waitcnt lgkmcnt(1)
    v_dot2_f32_bf16 v112, v104, v99, 0
    v_dot2_f32_bf16 v113, v104, v106, 0
    v_dot2_f32_bf16 v114, v105, v99, 0
    v_dot2_f32_bf16 v115, v105, v106, 0
    s_waitcnt lgkmcnt(0)
    v_dot2_f32_bf16 v112, v100, v98, v112
    v_dot2_f32_bf16 v113, v101, v98, v113
    v_dot2_f32_bf16 v114, v102, v98, v114
    v_dot2_f32_bf16 v115, v103, v98, v115
    s_waitcnt vmcnt(0)
    v_lshlrev_b32 v108, 16, v26
    v_and_b32 v109, s3, v26
    v_lshlrev_b32 v110, 16, v27
    v_and_b32 v111, s3, v27
    s_cmp_lg_u32 s6, 0
    v_mul_f32 v108, v108, v112
    v_mul_f32 v109, v109, v113
    v_mul_f32 v110, v110, v114
    v_mul_f32 v111, v111, v115
    s_cbranch_scc1 P2_FL40
    v_cvt_rpi_i32_f32 v112, v108
    ds_add_u32 v94, v112 offset:0
    v_cvt_rpi_i32_f32 v113, v109
    ds_add_u32 v94, v113 offset:6272
    v_cvt_rpi_i32_f32 v114, v110
    ds_add_u32 v94, v114 offset:12544
    v_cvt_rpi_i32_f32 v115, v111
    ds_add_u32 v94, v115 offset:18816
    s_branch P2_SK40
P2_FL40:
    ds_add_f32 v94, v108 offset:0
    ds_add_f32 v94, v109 offset:6272
    ds_add_f32 v94, v110 offset:12544
    ds_add_f32 v94, v111 offset:18816
P2_SK40:
    s_mov_b64 exec, -1
    s_waitcnt vmcnt(0)
    s_waitcnt vmcnt(0)
    s_add_u32 s77, s77, 256
    s_branch P2_LOOP1
P2_LOOP_END1:
    s_add_u32 s78, s78, 512
P2_LOOP2:
    s_sub_i32 s86, s74, s78
    s_cmp_le_i32 s86, 0
    s_cbranch_scc1 P2_LOOP_END2
    ds_write_b64 v2, v[18:19] offset:0
    ds_write_b64 v2, v[18:19] offset:512
    s_add_u32 s15, s78, 0
    v_subrev_u32 v12, s15, v6
    v_cmp_gt_u32 vcc, 256, v12
    v_lshl_add_u32 v12, v12, 2, s7
    s_mov_b64 exec, vcc
    ds_write_b32 v12, v10
    s_mov_b64 exec, -1
    ds_read_b32 v20, v1 offset:0
    ds_read_b32 v22, v1 offset:256
    ds_read_b32 v24, v1 offset:512
    ds_read_b32 v26, v1 offset:768
    s_lshl_b32 s15, s15, 3
    s_waitcnt lgkmcnt(0)
    v_max_u32_dpp v20, v20, v20 row_shr:1 row_mask:0xf bank_mask:0xf bound_ctrl:0
    v_max_u32_dpp v22, v22, v22 row_shr:1 row_mask:0xf bank_mask:0xf bound_ctrl:0
    v_max_u32_dpp v24, v24, v24 row_shr:1 row_mask:0xf bank_mask:0xf bound_ctrl:0
    v_max_u32_dpp v26, v26, v26 row_shr:1 row_mask:0xf bank_mask:0xf bound_ctrl:0
    v_max_u32_dpp v20, v20, v20 row_shr:2 row_mask:0xf bank_mask:0xf bound_ctrl:0
    v_max_u32_dpp v22, v22, v22 row_shr:2 row_mask:0xf bank_mask:0xf bound_ctrl:0
    v_max_u32_dpp v24, v24, v24 row_shr:2 row_mask:0xf bank_mask:0xf bound_ctrl:0
    v_max_u32_dpp v26, v26, v26 row_shr:2 row_mask:0xf bank_mask:0xf bound_ctrl:0
    v_max_u32_dpp v20, v20, v20 row_shr:4 row_mask:0xf bank_mask:0xf bound_ctrl:0
    v_max_u32_dpp v22, v22, v22 row_shr:4 row_mask:0xf bank_mask:0xf bound_ctrl:0
    v_max_u32_dpp v24, v24, v24 row_shr:4 row_mask:0xf bank_mask:0xf bound_ctrl:0
    v_max_u32_dpp v26, v26, v26 row_shr:4 row_mask:0xf bank_mask:0xf bound_ctrl:0
    v_max_u32_dpp v20, v20, v20 row_shr:8 row_mask:0xf bank_mask:0xf bound_ctrl:0
    v_max_u32_dpp v22, v22, v22 row_shr:8 row_mask:0xf bank_mask:0xf bound_ctrl:0
    v_max_u32_dpp v24, v24, v24 row_shr:8 row_mask:0xf bank_mask:0xf bound_ctrl:0
    v_max_u32_dpp v26, v26, v26 row_shr:8 row_mask:0xf bank_mask:0xf bound_ctrl:0
    v_max_u32_dpp v20, v20, v20 row_bcast:15 row_mask:0xa bank_mask:0xf
    v_max_u32_dpp v22, v22, v22 row_bcast:15 row_mask:0xa bank_mask:0xf
    v_max_u32_dpp v24, v24, v24 row_bcast:15 row_mask:0xa bank_mask:0xf
    v_max_u32_dpp v26, v26, v26 row_bcast:15 row_mask:0xa bank_mask:0xf
    v_max_u32_dpp v20, v20, v20 row_bcast:31 row_mask:0xc bank_mask:0xf
    v_max_u32_dpp v22, v22, v22 row_bcast:31 row_mask:0xc bank_mask:0xf
    v_max_u32_dpp v24, v24, v24 row_bcast:31 row_mask:0xc bank_mask:0xf
    v_max_u32_dpp v26, v26, v26 row_bcast:31 row_mask:0xc bank_mask:0xf
    v_max_u32 v20, s82, v20
    s_nop 0
    v_readlane_b32 s82, v20, 63
    v_add3_u32 v20, v20, v3, s15
    s_add_u32 s15, s15, 512
    s_max_i32 s14, s86, 0
    s_bfm_b64 exec, s14, 0
    s_cmp_ge_i32 s14, 64
    s_cselect_b64 exec, -1, exec
    buffer_load_dwordx2 v[20:21], v20, s[16:19], 0 offen
    s_mov_b64 exec, -1
    v_max_u32 v22, s82, v22
    s_nop 0
    v_readlane_b32 s82, v22, 63
    v_add3_u32 v22, v22, v3, s15
    s_add_u32 s15, s15, 512
    s_sub_i32 s14, s86, 64
    s_max_i32 s14, s14, 0
    s_bfm_b64 exec, s14, 0
    s_cmp_ge_i32 s14, 64
    s_cselect_b64 exec, -1, exec
    buffer_load_dwordx2 v[22:23], v22, s[16:19], 0 offen
    s_mov_b64 exec, -1
    v_max_u32 v24, s82, v24
    s_nop 0
    v_readlane_b32 s82, v24, 63
    v_add3_u32 v24, v24, v3, s15
    s_add_u32 s15, s15, 512
    s_sub_i32 s14, s86, 128
    s_max_i32 s14, s14, 0
    s_bfm_b64 exec, s14, 0
    s_cmp_ge_i32 s14, 64
    s_cselect_b64 exec, -1, exec
    buffer_load_dwordx2 v[24:25], v24, s[16:19], 0 offen
    s_mov_b64 exec, -1
    v_max_u32 v26, s82, v26
    s_nop 0
    v_readlane_b32 s82, v26, 63
    v_add3_u32 v26, v26, v3, s15
    s_add_u32 s15, s15, 512
    s_sub_i32 s14, s86, 192
    s_max_i32 s14, s14, 0
    s_bfm_b64 exec, s14, 0
    s_cmp_ge_i32 s14, 64
    s_cselect_b64 exec, -1, exec
    buffer_load_dwordx2 v[26:27], v26, s[16:19], 0 offen
    s_mov_b64 exec, -1
    s_waitcnt vmcnt(3)
    s_max_i32 s14, s86, 0
    s_bfm_b64 exec, s14, 0
    s_cmp_ge_i32 s14, 64
    s_cselect_b64 exec, -1, exec
    v_mov_b32 v68, v21
    buffer_load_dwordx2 v[20:21], v20, s[20:23], 0 offen
    s_mov_b64 exec, -1
    s_waitcnt vmcnt(3)
    s_sub_i32 s14, s86, 64
    s_max_i32 s14, s14, 0
    s_bfm_b64 exec, s14, 0
    s_cmp_ge_i32 s14, 64
    s_cselect_b64 exec, -1, exec
    v_mov_b32 v69, v23
    buffer_load_dwordx2 v[22:23], v22, s[20:23], 0 offen
    s_mov_b64 exec, -1
    s_waitcnt vmcnt(3)
    s_sub_i32 s14, s86, 128
    s_max_i32 s14, s14, 0
    s_bfm_b64 exec, s14, 0
    s_cmp_ge_i32 s14, 64
    s_cselect_b64 exec, -1, exec
    v_mov_b32 v70, v25
    buffer_load_dwordx2 v[24:25], v24, s[20:23], 0 offen
    s_mov_b64 exec, -1
    s_waitcnt vmcnt(3)
    s_sub_i32 s14, s86, 192
    s_max_i32 s14, s14, 0
    s_bfm_b64 exec, s14, 0
    s_cmp_ge_i32 s14, 64
    s_cselect_b64 exec, -1, exec
    v_mov_b32 v71, v27
    buffer_load_dwordx2 v[26:27], v26, s[20:23], 0 offen
    s_mov_b64 exec, -1
    s_max_i32 s14, s86, 0
    s_bfm_b64 exec, s14, 0
    s_cmp_ge_i32 s14, 64
    s_cselect_b64 exec, -1, exec
    s_cbranch_execz P2_SK41
    v_and_b32 v94, 0xffff, v68
    v_add_u32 v93, v94, v94
    v_add_u32 v92, v93, v93
    ds_read_b64 v[104:105], v93 offset:25088
    ds_read_b128 v[100:103], v92 offset:37632
    v_and_b32 v95, s3, v68
    v_mul_f32 v96, 0.15915494, v95
    v_mul_f32 v97, 0x40400000, v95
    v_cos_f32 v96, v96
    v_cvt_pk_bf16_f32 v97, 0, v97
    v_mul_f32 v97, 0.15915494, v97
    v_mul_f32 v95, v96, v96
    v_cos_f32 v97, v97
    v_fma_f32 v95, v95, 2.0, -1.0
    v_cvt_pk_bf16_f32 v98, v96, v95
    v_cvt_pk_bf16_f32 v99, v97, 0
    v_cvt_pk_bf16_f32 v106, 0, v97
    s_waitcnt lgkmcnt(1)
    v_dot2_f32_bf16 v112, v104, v99, 0
    v_dot2_f32_bf16 v113, v104, v106, 0
    v_dot2_f32_bf16 v114, v105, v99, 0
    v_dot2_f32_bf16 v115, v105, v106, 0
    s_waitcnt lgkmcnt(0)
    v_dot2_f32_bf16 v112, v100, v98, v112
    v_dot2_f32_bf16 v113, v101, v98, v113
    v_dot2_f32_bf16 v114, v102, v98, v114
    v_dot2_f32_bf16 v115, v103, v98, v115
    s_waitcnt vmcnt(3)
    v_lshlrev_b32 v108, 16, v20
    v_and_b32 v109, s3, v20
    v_lshlrev_b32 v110, 16, v21
    v_and_b32 v111, s3, v21
    s_cmp_lg_u32 s6, 0
    v_mul_f32 v108, v108, v112
    v_mul_f32 v109, v109, v113
    v_mul_f32 v110, v110, v114
    v_mul_f32 v111, v111, v115
    s_cbranch_scc1 P2_FL41
    v_cvt_rpi_i32_f32 v112, v108
    ds_add_u32 v94, v112 offset:0
    v_cvt_rpi_i32_f32 v113, v109
    ds_add_u32 v94, v113 offset:6272
    v_cvt_rpi_i32_f32 v114, v110
    ds_add_u32 v94, v114 offset:12544
    v_cvt_rpi_i32_f32 v115, v111
    ds_add_u32 v94, v115 offset:18816
    s_branch P2_SK41
P2_FL41:
    ds_add_f32 v94, v108 offset:0
    ds_add_f32 v94, v109 offset:6272
    ds_add_f32 v94, v110 offset:12544
    ds_add_f32 v94, v111 offset:18816
P2_SK41:
    s_mov_b64 exec, -1
    s_waitcnt vmcnt(3)
    s_sub_i32 s14, s86, 64
    s_max_i32 s14, s14, 0
    s_bfm_b64 exec, s14, 0
    s_cmp_ge_i32 s14, 64
    s_cselect_b64 exec, -1, exec
    s_cbranch_execz P2_SK42
    v_and_b32 v94, 0xffff, v69
    v_add_u32 v93, v94, v94
    v_add_u32 v92, v93, v93
    ds_read_b64 v[104:105], v93 offset:25088
    ds_read_b128 v[100:103], v92 offset:37632
    v_and_b32 v95, s3, v69
    v_mul_f32 v96, 0.15915494, v95
    v_mul_f32 v97, 0x40400000, v95
    v_cos_f32 v96, v96
    v_cvt_pk_bf16_f32 v97, 0, v97
    v_mul_f32 v97, 0.15915494, v97
    v_mul_f32 v95, v96, v96
    v_cos_f32 v97, v97
    v_fma_f32 v95, v95, 2.0, -1.0
    v_cvt_pk_bf16_f32 v98, v96, v95
    v_cvt_pk_bf16_f32 v99, v97, 0
    v_cvt_pk_bf16_f32 v106, 0, v97
    s_waitcnt lgkmcnt(1)
    v_dot2_f32_bf16 v112, v104, v99, 0
    v_dot2_f32_bf16 v113, v104, v106, 0
    v_dot2_f32_bf16 v114, v105, v99, 0
    v_dot2_f32_bf16 v115, v105, v106, 0
    s_waitcnt lgkmcnt(0)
    v_dot2_f32_bf16 v112, v100, v98, v112
    v_dot2_f32_bf16 v113, v101, v98, v113
    v_dot2_f32_bf16 v114, v102, v98, v114
    v_dot2_f32_bf16 v115, v103, v98, v115
    s_waitcnt vmcnt(2)
    v_lshlrev_b32 v108, 16, v22
    v_and_b32 v109, s3, v22
    v_lshlrev_b32 v110, 16, v23
    v_and_b32 v111, s3, v23
    s_cmp_lg_u32 s6, 0
    v_mul_f32 v108, v108, v112
    v_mul_f32 v109, v109, v113
    v_mul_f32 v110, v110, v114
    v_mul_f32 v111, v111, v115
    s_cbranch_scc1 P2_FL42
    v_cvt_rpi_i32_f32 v112, v108
    ds_add_u32 v94, v112 offset:0
    v_cvt_rpi_i32_f32 v113, v109
    ds_add_u32 v94, v113 offset:6272
    v_cvt_rpi_i32_f32 v114, v110
    ds_add_u32 v94, v114 offset:12544
    v_cvt_rpi_i32_f32 v115, v111
    ds_add_u32 v94, v115 offset:18816
    s_branch P2_SK42
P2_FL42:
    ds_add_f32 v94, v108 offset:0
    ds_add_f32 v94, v109 offset:6272
    ds_add_f32 v94, v110 offset:12544
    ds_add_f32 v94, v111 offset:18816
P2_SK42:
    s_mov_b64 exec, -1
    s_waitcnt vmcnt(2)
    s_sub_i32 s14, s86, 128
    s_max_i32 s14, s14, 0
    s_bfm_b64 exec, s14, 0
    s_cmp_ge_i32 s14, 64
    s_cselect_b64 exec, -1, exec
    s_cbranch_execz P2_SK43
    v_and_b32 v94, 0xffff, v70
    v_add_u32 v93, v94, v94
    v_add_u32 v92, v93, v93
    ds_read_b64 v[104:105], v93 offset:25088
    ds_read_b128 v[100:103], v92 offset:37632
    v_and_b32 v95, s3, v70
    v_mul_f32 v96, 0.15915494, v95
    v_mul_f32 v97, 0x40400000, v95
    v_cos_f32 v96, v96
    v_cvt_pk_bf16_f32 v97, 0, v97
    v_mul_f32 v97, 0.15915494, v97
    v_mul_f32 v95, v96, v96
    v_cos_f32 v97, v97
    v_fma_f32 v95, v95, 2.0, -1.0
    v_cvt_pk_bf16_f32 v98, v96, v95
    v_cvt_pk_bf16_f32 v99, v97, 0
    v_cvt_pk_bf16_f32 v106, 0, v97
    s_waitcnt lgkmcnt(1)
    v_dot2_f32_bf16 v112, v104, v99, 0
    v_dot2_f32_bf16 v113, v104, v106, 0
    v_dot2_f32_bf16 v114, v105, v99, 0
    v_dot2_f32_bf16 v115, v105, v106, 0
    s_waitcnt lgkmcnt(0)
    v_dot2_f32_bf16 v112, v100, v98, v112
    v_dot2_f32_bf16 v113, v101, v98, v113
    v_dot2_f32_bf16 v114, v102, v98, v114
    v_dot2_f32_bf16 v115, v103, v98, v115
    s_waitcnt vmcnt(1)
    v_lshlrev_b32 v108, 16, v24
    v_and_b32 v109, s3, v24
    v_lshlrev_b32 v110, 16, v25
    v_and_b32 v111, s3, v25
    s_cmp_lg_u32 s6, 0
    v_mul_f32 v108, v108, v112
    v_mul_f32 v109, v109, v113
    v_mul_f32 v110, v110, v114
    v_mul_f32 v111, v111, v115
    s_cbranch_scc1 P2_FL43
    v_cvt_rpi_i32_f32 v112, v108
    ds_add_u32 v94, v112 offset:0
    v_cvt_rpi_i32_f32 v113, v109
    ds_add_u32 v94, v113 offset:6272
    v_cvt_rpi_i32_f32 v114, v110
    ds_add_u32 v94, v114 offset:12544
    v_cvt_rpi_i32_f32 v115, v111
    ds_add_u32 v94, v115 offset:18816
    s_branch P2_SK43
P2_FL43:
    ds_add_f32 v94, v108 offset:0
    ds_add_f32 v94, v109 offset:6272
    ds_add_f32 v94, v110 offset:12544
    ds_add_f32 v94, v111 offset:18816
P2_SK43:
    s_mov_b64 exec, -1
    s_waitcnt vmcnt(1)
    s_sub_i32 s14, s86, 192
    s_max_i32 s14, s14, 0
    s_bfm_b64 exec, s14, 0
    s_cmp_ge_i32 s14, 64
    s_cselect_b64 exec, -1, exec
    s_cbranch_execz P2_SK44
    v_and_b32 v94, 0xffff, v71
    v_add_u32 v93, v94, v94
    v_add_u32 v92, v93, v93
    ds_read_b64 v[104:105], v93 offset:25088
    ds_read_b128 v[100:103], v92 offset:37632
    v_and_b32 v95, s3, v71
    v_mul_f32 v96, 0.15915494, v95
    v_mul_f32 v97, 0x40400000, v95
    v_cos_f32 v96, v96
    v_cvt_pk_bf16_f32 v97, 0, v97
    v_mul_f32 v97, 0.15915494, v97
    v_mul_f32 v95, v96, v96
    v_cos_f32 v97, v97
    v_fma_f32 v95, v95, 2.0, -1.0
    v_cvt_pk_bf16_f32 v98, v96, v95
    v_cvt_pk_bf16_f32 v99, v97, 0
    v_cvt_pk_bf16_f32 v106, 0, v97
    s_waitcnt lgkmcnt(1)
    v_dot2_f32_bf16 v112, v104, v99, 0
    v_dot2_f32_bf16 v113, v104, v106, 0
    v_dot2_f32_bf16 v114, v105, v99, 0
    v_dot2_f32_bf16 v115, v105, v106, 0
    s_waitcnt lgkmcnt(0)
    v_dot2_f32_bf16 v112, v100, v98, v112
    v_dot2_f32_bf16 v113, v101, v98, v113
    v_dot2_f32_bf16 v114, v102, v98, v114
    v_dot2_f32_bf16 v115, v103, v98, v115
    s_waitcnt vmcnt(0)
    v_lshlrev_b32 v108, 16, v26
    v_and_b32 v109, s3, v26
    v_lshlrev_b32 v110, 16, v27
    v_and_b32 v111, s3, v27
    s_cmp_lg_u32 s6, 0
    v_mul_f32 v108, v108, v112
    v_mul_f32 v109, v109, v113
    v_mul_f32 v110, v110, v114
    v_mul_f32 v111, v111, v115
    s_cbranch_scc1 P2_FL44
    v_cvt_rpi_i32_f32 v112, v108
    ds_add_u32 v94, v112 offset:0
    v_cvt_rpi_i32_f32 v113, v109
    ds_add_u32 v94, v113 offset:6272
    v_cvt_rpi_i32_f32 v114, v110
    ds_add_u32 v94, v114 offset:12544
    v_cvt_rpi_i32_f32 v115, v111
    ds_add_u32 v94, v115 offset:18816
    s_branch P2_SK44
P2_FL44:
    ds_add_f32 v94, v108 offset:0
    ds_add_f32 v94, v109 offset:6272
    ds_add_f32 v94, v110 offset:12544
    ds_add_f32 v94, v111 offset:18816
P2_SK44:
    s_mov_b64 exec, -1
    s_waitcnt vmcnt(0)
    s_waitcnt vmcnt(0)
    s_add_u32 s78, s78, 256
    s_branch P2_LOOP2
P2_LOOP_END2:
    s_add_u32 s79, s79, 512
P2_LOOP3:
    s_sub_i32 s87, s75, s79
    s_cmp_le_i32 s87, 0
    s_cbranch_scc1 P2_LOOP_END3
    ds_write_b64 v2, v[18:19] offset:0
    ds_write_b64 v2, v[18:19] offset:512
    s_add_u32 s15, s79, 0
    v_subrev_u32 v12, s15, v7
    v_cmp_gt_u32 vcc, 256, v12
    v_lshl_add_u32 v12, v12, 2, s7
    s_mov_b64 exec, vcc
    ds_write_b32 v12, v11
    s_mov_b64 exec, -1
    ds_read_b32 v20, v1 offset:0
    ds_read_b32 v22, v1 offset:256
    ds_read_b32 v24, v1 offset:512
    ds_read_b32 v26, v1 offset:768
    s_lshl_b32 s15, s15, 3
    s_waitcnt lgkmcnt(0)
    v_max_u32_dpp v20, v20, v20 row_shr:1 row_mask:0xf bank_mask:0xf bound_ctrl:0
    v_max_u32_dpp v22, v22, v22 row_shr:1 row_mask:0xf bank_mask:0xf bound_ctrl:0
    v_max_u32_dpp v24, v24, v24 row_shr:1 row_mask:0xf bank_mask:0xf bound_ctrl:0
    v_max_u32_dpp v26, v26, v26 row_shr:1 row_mask:0xf bank_mask:0xf bound_ctrl:0
    v_max_u32_dpp v20, v20, v20 row_shr:2 row_mask:0xf bank_mask:0xf bound_ctrl:0
    v_max_u32_dpp v22, v22, v22 row_shr:2 row_mask:0xf bank_mask:0xf bound_ctrl:0
    v_max_u32_dpp v24, v24, v24 row_shr:2 row_mask:0xf bank_mask:0xf bound_ctrl:0
    v_max_u32_dpp v26, v26, v26 row_shr:2 row_mask:0xf bank_mask:0xf bound_ctrl:0
    v_max_u32_dpp v20, v20, v20 row_shr:4 row_mask:0xf bank_mask:0xf bound_ctrl:0
    v_max_u32_dpp v22, v22, v22 row_shr:4 row_mask:0xf bank_mask:0xf bound_ctrl:0
    v_max_u32_dpp v24, v24, v24 row_shr:4 row_mask:0xf bank_mask:0xf bound_ctrl:0
    v_max_u32_dpp v26, v26, v26 row_shr:4 row_mask:0xf bank_mask:0xf bound_ctrl:0
    v_max_u32_dpp v20, v20, v20 row_shr:8 row_mask:0xf bank_mask:0xf bound_ctrl:0
    v_max_u32_dpp v22, v22, v22 row_shr:8 row_mask:0xf bank_mask:0xf bound_ctrl:0
    v_max_u32_dpp v24, v24, v24 row_shr:8 row_mask:0xf bank_mask:0xf bound_ctrl:0
    v_max_u32_dpp v26, v26, v26 row_shr:8 row_mask:0xf bank_mask:0xf bound_ctrl:0
    v_max_u32_dpp v20, v20, v20 row_bcast:15 row_mask:0xa bank_mask:0xf
    v_max_u32_dpp v22, v22, v22 row_bcast:15 row_mask:0xa bank_mask:0xf
    v_max_u32_dpp v24, v24, v24 row_bcast:15 row_mask:0xa bank_mask:0xf
    v_max_u32_dpp v26, v26, v26 row_bcast:15 row_mask:0xa bank_mask:0xf
    v_max_u32_dpp v20, v20, v20 row_bcast:31 row_mask:0xc bank_mask:0xf
    v_max_u32_dpp v22, v22, v22 row_bcast:31 row_mask:0xc bank_mask:0xf
    v_max_u32_dpp v24, v24, v24 row_bcast:31 row_mask:0xc bank_mask:0xf
    v_max_u32_dpp v26, v26, v26 row_bcast:31 row_mask:0xc bank_mask:0xf
    v_max_u32 v20, s83, v20
    s_nop 0
    v_readlane_b32 s83, v20, 63
    v_add3_u32 v20, v20, v3, s15
    s_add_u32 s15, s15, 512
    s_max_i32 s14, s87, 0
    s_bfm_b64 exec, s14, 0
    s_cmp_ge_i32 s14, 64
    s_cselect_b64 exec, -1, exec
    buffer_load_dwordx2 v[20:21], v20, s[16:19], 0 offen
    s_mov_b64 exec, -1
    v_max_u32 v22, s83, v22
    s_nop 0
    v_readlane_b32 s83, v22, 63
    v_add3_u32 v22, v22, v3, s15
    s_add_u32 s15, s15, 512
    s_sub_i32 s14, s87, 64
    s_max_i32 s14, s14, 0
    s_bfm_b64 exec, s14, 0
    s_cmp_ge_i32 s14, 64
    s_cselect_b64 exec, -1, exec
    buffer_load_dwordx2 v[22:23], v22, s[16:19], 0 offen
    s_mov_b64 exec, -1
    v_max_u32 v24, s83, v24
    s_nop 0
    v_readlane_b32 s83, v24, 63
    v_add3_u32 v24, v24, v3, s15
    s_add_u32 s15, s15, 512
    s_sub_i32 s14, s87, 128
    s_max_i32 s14, s14, 0
    s_bfm_b64 exec, s14, 0
    s_cmp_ge_i32 s14, 64
    s_cselect_b64 exec, -1, exec
    buffer_load_dwordx2 v[24:25], v24, s[16:19], 0 offen
    s_mov_b64 exec, -1
    v_max_u32 v26, s83, v26
    s_nop 0
    v_readlane_b32 s83, v26, 63
    v_add3_u32 v26, v26, v3, s15
    s_add_u32 s15, s15, 512
    s_sub_i32 s14, s87, 192
    s_max_i32 s14, s14, 0
    s_bfm_b64 exec, s14, 0
    s_cmp_ge_i32 s14, 64
    s_cselect_b64 exec, -1, exec
    buffer_load_dwordx2 v[26:27], v26, s[16:19], 0 offen
    s_mov_b64 exec, -1
    s_waitcnt vmcnt(3)
    s_max_i32 s14, s87, 0
    s_bfm_b64 exec, s14, 0
    s_cmp_ge_i32 s14, 64
    s_cselect_b64 exec, -1, exec
    v_mov_b32 v68, v21
    buffer_load_dwordx2 v[20:21], v20, s[20:23], 0 offen
    s_mov_b64 exec, -1
    s_waitcnt vmcnt(3)
    s_sub_i32 s14, s87, 64
    s_max_i32 s14, s14, 0
    s_bfm_b64 exec, s14, 0
    s_cmp_ge_i32 s14, 64
    s_cselect_b64 exec, -1, exec
    v_mov_b32 v69, v23
    buffer_load_dwordx2 v[22:23], v22, s[20:23], 0 offen
    s_mov_b64 exec, -1
    s_waitcnt vmcnt(3)
    s_sub_i32 s14, s87, 128
    s_max_i32 s14, s14, 0
    s_bfm_b64 exec, s14, 0
    s_cmp_ge_i32 s14, 64
    s_cselect_b64 exec, -1, exec
    v_mov_b32 v70, v25
    buffer_load_dwordx2 v[24:25], v24, s[20:23], 0 offen
    s_mov_b64 exec, -1
    s_waitcnt vmcnt(3)
    s_sub_i32 s14, s87, 192
    s_max_i32 s14, s14, 0
    s_bfm_b64 exec, s14, 0
    s_cmp_ge_i32 s14, 64
    s_cselect_b64 exec, -1, exec
    v_mov_b32 v71, v27
    buffer_load_dwordx2 v[26:27], v26, s[20:23], 0 offen
    s_mov_b64 exec, -1
    s_max_i32 s14, s87, 0
    s_bfm_b64 exec, s14, 0
    s_cmp_ge_i32 s14, 64
    s_cselect_b64 exec, -1, exec
    s_cbranch_execz P2_SK45
    v_and_b32 v94, 0xffff, v68
    v_add_u32 v93, v94, v94
    v_add_u32 v92, v93, v93
    ds_read_b64 v[104:105], v93 offset:25088
    ds_read_b128 v[100:103], v92 offset:37632
    v_and_b32 v95, s3, v68
    v_mul_f32 v96, 0.15915494, v95
    v_mul_f32 v97, 0x40400000, v95
    v_cos_f32 v96, v96
    v_cvt_pk_bf16_f32 v97, 0, v97
    v_mul_f32 v97, 0.15915494, v97
    v_mul_f32 v95, v96, v96
    v_cos_f32 v97, v97
    v_fma_f32 v95, v95, 2.0, -1.0
    v_cvt_pk_bf16_f32 v98, v96, v95
    v_cvt_pk_bf16_f32 v99, v97, 0
    v_cvt_pk_bf16_f32 v106, 0, v97
    s_waitcnt lgkmcnt(1)
    v_dot2_f32_bf16 v112, v104, v99, 0
    v_dot2_f32_bf16 v113, v104, v106, 0
    v_dot2_f32_bf16 v114, v105, v99, 0
    v_dot2_f32_bf16 v115, v105, v106, 0
    s_waitcnt lgkmcnt(0)
    v_dot2_f32_bf16 v112, v100, v98, v112
    v_dot2_f32_bf16 v113, v101, v98, v113
    v_dot2_f32_bf16 v114, v102, v98, v114
    v_dot2_f32_bf16 v115, v103, v98, v115
    s_waitcnt vmcnt(3)
    v_lshlrev_b32 v108, 16, v20
    v_and_b32 v109, s3, v20
    v_lshlrev_b32 v110, 16, v21
    v_and_b32 v111, s3, v21
    s_cmp_lg_u32 s6, 0
    v_mul_f32 v108, v108, v112
    v_mul_f32 v109, v109, v113
    v_mul_f32 v110, v110, v114
    v_mul_f32 v111, v111, v115
    s_cbranch_scc1 P2_FL45
    v_cvt_rpi_i32_f32 v112, v108
    ds_add_u32 v94, v112 offset:0
    v_cvt_rpi_i32_f32 v113, v109
    ds_add_u32 v94, v113 offset:6272
    v_cvt_rpi_i32_f32 v114, v110
    ds_add_u32 v94, v114 offset:12544
    v_cvt_rpi_i32_f32 v115, v111
    ds_add_u32 v94, v115 offset:18816
    s_branch P2_SK45
P2_FL45:
    ds_add_f32 v94, v108 offset:0
    ds_add_f32 v94, v109 offset:6272
    ds_add_f32 v94, v110 offset:12544
    ds_add_f32 v94, v111 offset:18816
P2_SK45:
    s_mov_b64 exec, -1
    s_waitcnt vmcnt(3)
    s_sub_i32 s14, s87, 64
    s_max_i32 s14, s14, 0
    s_bfm_b64 exec, s14, 0
    s_cmp_ge_i32 s14, 64
    s_cselect_b64 exec, -1, exec
    s_cbranch_execz P2_SK46
    v_and_b32 v94, 0xffff, v69
    v_add_u32 v93, v94, v94
    v_add_u32 v92, v93, v93
    ds_read_b64 v[104:105], v93 offset:25088
    ds_read_b128 v[100:103], v92 offset:37632
    v_and_b32 v95, s3, v69
    v_mul_f32 v96, 0.15915494, v95
    v_mul_f32 v97, 0x40400000, v95
    v_cos_f32 v96, v96
    v_cvt_pk_bf16_f32 v97, 0, v97
    v_mul_f32 v97, 0.15915494, v97
    v_mul_f32 v95, v96, v96
    v_cos_f32 v97, v97
    v_fma_f32 v95, v95, 2.0, -1.0
    v_cvt_pk_bf16_f32 v98, v96, v95
    v_cvt_pk_bf16_f32 v99, v97, 0
    v_cvt_pk_bf16_f32 v106, 0, v97
    s_waitcnt lgkmcnt(1)
    v_dot2_f32_bf16 v112, v104, v99, 0
    v_dot2_f32_bf16 v113, v104, v106, 0
    v_dot2_f32_bf16 v114, v105, v99, 0
    v_dot2_f32_bf16 v115, v105, v106, 0
    s_waitcnt lgkmcnt(0)
    v_dot2_f32_bf16 v112, v100, v98, v112
    v_dot2_f32_bf16 v113, v101, v98, v113
    v_dot2_f32_bf16 v114, v102, v98, v114
    v_dot2_f32_bf16 v115, v103, v98, v115
    s_waitcnt vmcnt(2)
    v_lshlrev_b32 v108, 16, v22
    v_and_b32 v109, s3, v22
    v_lshlrev_b32 v110, 16, v23
    v_and_b32 v111, s3, v23
    s_cmp_lg_u32 s6, 0
    v_mul_f32 v108, v108, v112
    v_mul_f32 v109, v109, v113
    v_mul_f32 v110, v110, v114
    v_mul_f32 v111, v111, v115
    s_cbranch_scc1 P2_FL46
    v_cvt_rpi_i32_f32 v112, v108
    ds_add_u32 v94, v112 offset:0
    v_cvt_rpi_i32_f32 v113, v109
    ds_add_u32 v94, v113 offset:6272
    v_cvt_rpi_i32_f32 v114, v110
    ds_add_u32 v94, v114 offset:12544
    v_cvt_rpi_i32_f32 v115, v111
    ds_add_u32 v94, v115 offset:18816
    s_branch P2_SK46
P2_FL46:
    ds_add_f32 v94, v108 offset:0
    ds_add_f32 v94, v109 offset:6272
    ds_add_f32 v94, v110 offset:12544
    ds_add_f32 v94, v111 offset:18816
P2_SK46:
    s_mov_b64 exec, -1
    s_waitcnt vmcnt(2)
    s_sub_i32 s14, s87, 128
    s_max_i32 s14, s14, 0
    s_bfm_b64 exec, s14, 0
    s_cmp_ge_i32 s14, 64
    s_cselect_b64 exec, -1, exec
    s_cbranch_execz P2_SK47
    v_and_b32 v94, 0xffff, v70
    v_add_u32 v93, v94, v94
    v_add_u32 v92, v93, v93
    ds_read_b64 v[104:105], v93 offset:25088
    ds_read_b128 v[100:103], v92 offset:37632
    v_and_b32 v95, s3, v70
    v_mul_f32 v96, 0.15915494, v95
    v_mul_f32 v97, 0x40400000, v95
    v_cos_f32 v96, v96
    v_cvt_pk_bf16_f32 v97, 0, v97
    v_mul_f32 v97, 0.15915494, v97
    v_mul_f32 v95, v96, v96
    v_cos_f32 v97, v97
    v_fma_f32 v95, v95, 2.0, -1.0
    v_cvt_pk_bf16_f32 v98, v96, v95
    v_cvt_pk_bf16_f32 v99, v97, 0
    v_cvt_pk_bf16_f32 v106, 0, v97
    s_waitcnt lgkmcnt(1)
    v_dot2_f32_bf16 v112, v104, v99, 0
    v_dot2_f32_bf16 v113, v104, v106, 0
    v_dot2_f32_bf16 v114, v105, v99, 0
    v_dot2_f32_bf16 v115, v105, v106, 0
    s_waitcnt lgkmcnt(0)
    v_dot2_f32_bf16 v112, v100, v98, v112
    v_dot2_f32_bf16 v113, v101, v98, v113
    v_dot2_f32_bf16 v114, v102, v98, v114
    v_dot2_f32_bf16 v115, v103, v98, v115
    s_waitcnt vmcnt(1)
    v_lshlrev_b32 v108, 16, v24
    v_and_b32 v109, s3, v24
    v_lshlrev_b32 v110, 16, v25
    v_and_b32 v111, s3, v25
    s_cmp_lg_u32 s6, 0
    v_mul_f32 v108, v108, v112
    v_mul_f32 v109, v109, v113
    v_mul_f32 v110, v110, v114
    v_mul_f32 v111, v111, v115
    s_cbranch_scc1 P2_FL47
    v_cvt_rpi_i32_f32 v112, v108
    ds_add_u32 v94, v112 offset:0
    v_cvt_rpi_i32_f32 v113, v109
    ds_add_u32 v94, v113 offset:6272
    v_cvt_rpi_i32_f32 v114, v110
    ds_add_u32 v94, v114 offset:12544
    v_cvt_rpi_i32_f32 v115, v111
    ds_add_u32 v94, v115 offset:18816
    s_branch P2_SK47
P2_FL47:
    ds_add_f32 v94, v108 offset:0
    ds_add_f32 v94, v109 offset:6272
    ds_add_f32 v94, v110 offset:12544
    ds_add_f32 v94, v111 offset:18816
P2_SK47:
    s_mov_b64 exec, -1
    s_waitcnt vmcnt(1)
    s_sub_i32 s14, s87, 192
    s_max_i32 s14, s14, 0
    s_bfm_b64 exec, s14, 0
    s_cmp_ge_i32 s14, 64
    s_cselect_b64 exec, -1, exec
    s_cbranch_execz P2_SK48
    v_and_b32 v94, 0xffff, v71
    v_add_u32 v93, v94, v94
    v_add_u32 v92, v93, v93
    ds_read_b64 v[104:105], v93 offset:25088
    ds_read_b128 v[100:103], v92 offset:37632
    v_and_b32 v95, s3, v71
    v_mul_f32 v96, 0.15915494, v95
    v_mul_f32 v97, 0x40400000, v95
    v_cos_f32 v96, v96
    v_cvt_pk_bf16_f32 v97, 0, v97
    v_mul_f32 v97, 0.15915494, v97
    v_mul_f32 v95, v96, v96
    v_cos_f32 v97, v97
    v_fma_f32 v95, v95, 2.0, -1.0
    v_cvt_pk_bf16_f32 v98, v96, v95
    v_cvt_pk_bf16_f32 v99, v97, 0
    v_cvt_pk_bf16_f32 v106, 0, v97
    s_waitcnt lgkmcnt(1)
    v_dot2_f32_bf16 v112, v104, v99, 0
    v_dot2_f32_bf16 v113, v104, v106, 0
    v_dot2_f32_bf16 v114, v105, v99, 0
    v_dot2_f32_bf16 v115, v105, v106, 0
    s_waitcnt lgkmcnt(0)
    v_dot2_f32_bf16 v112, v100, v98, v112
    v_dot2_f32_bf16 v113, v101, v98, v113
    v_dot2_f32_bf16 v114, v102, v98, v114
    v_dot2_f32_bf16 v115, v103, v98, v115
    s_waitcnt vmcnt(0)
    v_lshlrev_b32 v108, 16, v26
    v_and_b32 v109, s3, v26
    v_lshlrev_b32 v110, 16, v27
    v_and_b32 v111, s3, v27
    s_cmp_lg_u32 s6, 0
    v_mul_f32 v108, v108, v112
    v_mul_f32 v109, v109, v113
    v_mul_f32 v110, v110, v114
    v_mul_f32 v111, v111, v115
    s_cbranch_scc1 P2_FL48
    v_cvt_rpi_i32_f32 v112, v108
    ds_add_u32 v94, v112 offset:0
    v_cvt_rpi_i32_f32 v113, v109
    ds_add_u32 v94, v113 offset:6272
    v_cvt_rpi_i32_f32 v114, v110
    ds_add_u32 v94, v114 offset:12544
    v_cvt_rpi_i32_f32 v115, v111
    ds_add_u32 v94, v115 offset:18816
    s_branch P2_SK48
P2_FL48:
    ds_add_f32 v94, v108 offset:0
    ds_add_f32 v94, v109 offset:6272
    ds_add_f32 v94, v110 offset:12544
    ds_add_f32 v94, v111 offset:18816
P2_SK48:
    s_mov_b64 exec, -1
    s_waitcnt vmcnt(0)
    s_waitcnt vmcnt(0)
    s_add_u32 s79, s79, 256
    s_branch P2_LOOP3
P2_LOOP_END3:
    v_lshlrev_b32 v92, 3, v0
    s_mul_i32 s14, s4, 12544
    s_add_u32 s15, s14, 8192
    buffer_load_dwordx2 v[20:21], v92, s[48:51], s14 offen
    buffer_load_dwordx2 v[22:23], v92, s[48:51], s15 offen
    s_mov_b32 s42, 0x200000
    buffer_load_dwordx2 v[24:25], v16, s[28:31], s42 offen
    buffer_load_dwordx2 v[26:27], v17, s[28:31], s42 offen
    s_waitcnt lgkmcnt(0)
    s_barrier
    v_lshlrev_b32 v93, 2, v0
    ds_read_b32 v96, v93 offset:0
    ds_read_b32 v97, v93 offset:6272
    ds_read_b32 v98, v93 offset:12544
    ds_read_b32 v99, v93 offset:18816
    v_bfe_i32 v104, v14, 0, 8
    v_bfe_i32 v105, v14, 8, 8
    v_bfe_i32 v106, v14, 16, 8
    v_bfe_i32 v107, v14, 24, 8
    v_subrev_u32 v104, s8, v104
    v_subrev_u32 v105, s8, v105
    v_subrev_u32 v106, s8, v106
    v_subrev_u32 v107, s8, v107
    s_cmp_lg_u32 s6, 0
    s_waitcnt lgkmcnt(0)
    s_cbranch_scc1 P2_EF0
    v_cvt_f32_i32 v96, v96
    v_cvt_f32_i32 v97, v97
    v_cvt_f32_i32 v98, v98
    v_cvt_f32_i32 v99, v99
P2_EF0:
    v_ldexp_f32 v96, v96, v104
    v_ldexp_f32 v97, v97, v105
    v_ldexp_f32 v98, v98, v106
    v_ldexp_f32 v99, v99, v107
    v_cvt_pk_bf16_f32 v112, v96, v97
    v_cvt_pk_bf16_f32 v113, v98, v99
    v_dot2_f32_bf16 v104, v112, s56, 0
    v_dot2_f32_bf16 v105, v112, s57, 0
    v_dot2_f32_bf16 v106, v112, s58, 0
    v_dot2_f32_bf16 v107, v112, s59, 0
    v_dot2_f32_bf16 v104, v113, s60, v104
    v_dot2_f32_bf16 v105, v113, s61, v105
    v_dot2_f32_bf16 v106, v113, s62, v106
    v_dot2_f32_bf16 v107, v113, s63, v107
    s_waitcnt vmcnt(0)
    v_lshlrev_b32 v108, 16, v24
    v_and_b32 v109, s3, v24
    v_lshlrev_b32 v110, 16, v25
    v_and_b32 v111, s3, v25
    v_lshlrev_b32 v100, 16, v20
    v_and_b32 v101, s3, v20
    v_lshlrev_b32 v102, 16, v21
    v_and_b32 v103, s3, v21
    v_cvt_pk_bf16_f32 v104, 0, v104
    v_cvt_pk_bf16_f32 v105, 0, v105
    v_cvt_pk_bf16_f32 v106, 0, v106
    v_cvt_pk_bf16_f32 v107, 0, v107
    v_mul_f32 v104, v104, v108
    v_mul_f32 v105, v105, v109
    v_mul_f32 v106, v106, v110
    v_mul_f32 v107, v107, v111
    v_cvt_pk_bf16_f32 v104, 0, v104
    v_cvt_pk_bf16_f32 v105, 0, v105
    v_cvt_pk_bf16_f32 v106, 0, v106
    v_cvt_pk_bf16_f32 v107, 0, v107
    v_add_f32 v104, v104, v100
    v_add_f32 v105, v105, v101
    v_add_f32 v106, v106, v102
    v_add_f32 v107, v107, v103
    v_cvt_pk_bf16_f32 v112, v104, v105
    v_cvt_pk_bf16_f32 v113, v106, v107
    buffer_store_dwordx2 v[112:113], v92, s[44:47], s14 offen
    s_cmp_ge_u32 s5, 9
    s_cbranch_scc1 P2_FIN
    v_cmp_gt_u32 vcc, 544, v0
    s_mov_b64 exec, vcc
    v_lshlrev_b32 v93, 2, v0
    ds_read_b32 v96, v93 offset:4096
    ds_read_b32 v97, v93 offset:10368
    ds_read_b32 v98, v93 offset:16640
    ds_read_b32 v99, v93 offset:22912
    v_bfe_i32 v104, v15, 0, 8
    v_bfe_i32 v105, v15, 8, 8
    v_bfe_i32 v106, v15, 16, 8
    v_bfe_i32 v107, v15, 24, 8
    v_subrev_u32 v104, s8, v104
    v_subrev_u32 v105, s8, v105
    v_subrev_u32 v106, s8, v106
    v_subrev_u32 v107, s8, v107
    s_cmp_lg_u32 s6, 0
    s_waitcnt lgkmcnt(0)
    s_cbranch_scc1 P2_EF1
    v_cvt_f32_i32 v96, v96
    v_cvt_f32_i32 v97, v97
    v_cvt_f32_i32 v98, v98
    v_cvt_f32_i32 v99, v99
P2_EF1:
    v_ldexp_f32 v96, v96, v104
    v_ldexp_f32 v97, v97, v105
    v_ldexp_f32 v98, v98, v106
    v_ldexp_f32 v99, v99, v107
    v_cvt_pk_bf16_f32 v112, v96, v97
    v_cvt_pk_bf16_f32 v113, v98, v99
    v_dot2_f32_bf16 v104, v112, s56, 0
    v_dot2_f32_bf16 v105, v112, s57, 0
    v_dot2_f32_bf16 v106, v112, s58, 0
    v_dot2_f32_bf16 v107, v112, s59, 0
    v_dot2_f32_bf16 v104, v113, s60, v104
    v_dot2_f32_bf16 v105, v113, s61, v105
    v_dot2_f32_bf16 v106, v113, s62, v106
    v_dot2_f32_bf16 v107, v113, s63, v107
    v_lshlrev_b32 v108, 16, v26
    v_and_b32 v109, s3, v26
    v_lshlrev_b32 v110, 16, v27
    v_and_b32 v111, s3, v27
    v_lshlrev_b32 v100, 16, v22
    v_and_b32 v101, s3, v22
    v_lshlrev_b32 v102, 16, v23
    v_and_b32 v103, s3, v23
    v_cvt_pk_bf16_f32 v104, 0, v104
    v_cvt_pk_bf16_f32 v105, 0, v105
    v_cvt_pk_bf16_f32 v106, 0, v106
    v_cvt_pk_bf16_f32 v107, 0, v107
    v_mul_f32 v104, v104, v108
    v_mul_f32 v105, v105, v109
    v_mul_f32 v106, v106, v110
    v_mul_f32 v107, v107, v111
    v_cvt_pk_bf16_f32 v104, 0, v104
    v_cvt_pk_bf16_f32 v105, 0, v105
    v_cvt_pk_bf16_f32 v106, 0, v106
    v_cvt_pk_bf16_f32 v107, 0, v107
    v_add_f32 v104, v104, v100
    v_add_f32 v105, v105, v101
    v_add_f32 v106, v106, v102
    v_add_f32 v107, v107, v103
    v_cvt_pk_bf16_f32 v112, v104, v105
    v_cvt_pk_bf16_f32 v113, v106, v107
    buffer_store_dwordx2 v[112:113], v92, s[44:47], s15 offen
P2_FIN:
P2_END:
    s_endpgm
TEXT_END:
.section .rodata,"a"
.p2align 6
.amdhsa_kernel gp1_kernel
  .amdhsa_next_free_vgpr 152
  .amdhsa_next_free_sgpr 100
  .amdhsa_accum_offset 152
  .amdhsa_group_segment_fixed_size 0
  .amdhsa_kernarg_size 112
  .amdhsa_user_sgpr_count 2
  .amdhsa_user_sgpr_kernarg_segment_ptr 1
  .amdhsa_system_sgpr_workgroup_id_x 1
  .amdhsa_float_denorm_mode_32 3
  .amdhsa_float_denorm_mode_16_64 3
.end_amdhsa_kernel
.p2align 6
.amdhsa_kernel gp2_kernel
  .amdhsa_next_free_vgpr 116
  .amdhsa_next_free_sgpr 90
  .amdhsa_accum_offset 116
  .amdhsa_group_segment_fixed_size 0
  .amdhsa_kernarg_size 112
  .amdhsa_user_sgpr_count 2
  .amdhsa_user_sgpr_kernarg_segment_ptr 1
  .amdhsa_system_sgpr_workgroup_id_x 1
  .amdhsa_float_denorm_mode_32 3
  .amdhsa_float_denorm_mode_16_64 3
.end_amdhsa_kernel
```
